```python
import torch

def _softmax(x, axis=-1):
    return torch.softmax(x, dim=axis)
def _gelu(x):
    return torch.nn.functional.gelu(x, approximate="tanh")
def _silu(x):
    return torch.nn.functional.silu(x)
def _sigmoid(x):
    return torch.sigmoid(x)
def _layernorm(x, axis=-1, eps=1e-5):
    m = x.mean(dim=axis, keepdim=True)
    v = x.var(dim=axis, keepdim=True, unbiased=False)
    return (x - m) / torch.sqrt(v + eps)
def _scatter_add(tgt, idx, src, axis=0):
    return tgt.clone().index_add_(axis, idx, src)
def _segment_sum(src, seg, n):
    out = torch.zeros((n,) + src.shape[1:], dtype=src.dtype)
    return out.index_add_(0, seg, src)
def _pad(x, pw):
    flat = tuple(v for pair in reversed(pw) for v in pair)
    return torch.nn.functional.pad(x, flat)

kernel_name = 'standalone__sliding_block_cached__sampling'

def setup_inputs():

    _w = (lambda a: (lambda t: t.to(torch.bfloat16) if t.is_floating_point() else t)(torch.as_tensor(a)))
    B, Sq, D = 32, 1, 1024
    Hq, Hkv, Sk, Dh = 32, 4, 2048, 128
    assert Hq % Hkv == 0, (Hq, Hkv)
    return {
        "x": _w((lambda *s: torch.randn(*s, dtype=torch.bfloat16) * 0.8)(B, Sq, D)),
        "k_cache": _w((lambda *s: torch.randn(*s, dtype=torch.bfloat16) * 0.8)(B, Hkv, Sk, Dh)),
        "v_cache": _w((lambda *s: torch.randn(*s, dtype=torch.bfloat16) * 0.05)(B, Hkv, Sk, Dh)),
        "wq": _w((lambda *s: torch.randn(*s, dtype=torch.bfloat16) * 0.8)(D, Hq * Dh) * (D ** -0.5)),
        "wo": _w((lambda *s: torch.randn(*s, dtype=torch.bfloat16) * 0.05)(Hq * Dh, D) * ((Hq * Dh) ** -0.5)),
    }

def reference(x, k_cache, v_cache, wq, wo):
    B, Sq, D = x.shape
    Hq, Dh = 32, 128
    Hkv, Sk = k_cache.shape[1], k_cache.shape[2]
    W = min(4096, max(256, Sk // 4))
    rep = Hq // Hkv
    q = (lambda x, *d: x.permute(*d))((x @ wq).reshape(B, Sq, Hq, Dh), 0, 2, 1, 3)
    k = (lambda x, n, axis: torch.repeat_interleave(x, n, dim=axis))(k_cache[:, :, Sk - W:, :], rep, axis=1)
    v = (lambda x, n, axis: torch.repeat_interleave(x, n, dim=axis))(v_cache[:, :, Sk - W:, :], rep, axis=1)
    scores = torch.einsum("bhqd,bhkd->bhqk", q, k) * (Dh ** -0.5)
    p = _softmax(scores, axis=-1)
    o = torch.einsum("bhqk,bhkd->bhqd", p, v)
    return (lambda x, *d: x.permute(*d))(o, 0, 2, 1, 3).reshape(B, Sq, Hq * Dh) @ wo
```

```asm
; @launch grid=(256,1,1) block=(576,1,1) lds=163840
.amdgcn_target "amdgcn-amd-amdhsa--gfx950"
.text
.globl standalone__sliding_block_cached__sampling_kernel
.p2align 8
.type standalone__sliding_block_cached__sampling_kernel,@function
standalone__sliding_block_cached__sampling_kernel:
  s_cmp_ge_u32 s2, 256
  s_cbranch_scc1 L_end
  s_load_dwordx16 s[8:23], s[0:1], 0
  v_lshrrev_b32 v1, 6, v0
  v_and_b32 v0, 63, v0
  s_mov_b32 s26, 400000
  v_readfirstlane_b32 s3, v1
  s_and_b32 s65, s2, 7
  s_lshr_b32 s66, s2, 3
  s_and_b32 s58, s66, 1
  s_lshr_b32 s63, s66, 1
  s_lshl_b32 s68, s63, 3
  s_add_u32 s68, s68, s65
  s_and_b32 s57, s68, 3
  s_lshr_b32 s56, s68, 2
  s_and_b32 s59, s2, 63
  s_lshr_b32 s60, s2, 6
  s_lshl_b32 s64, s65, 1
  s_add_u32 s64, s64, s58
  s_lshr_b32 s61, s65, 1
  s_and_b32 s62, s64, 3
  s_cmp_eq_u32 s3, 8
  s_cbranch_scc0 L_worker
  v_lshrrev_b32 v2, 5, v0
  v_and_b32 v3, 31, v0
  v_xor_b32 v3, v3, v2
  v_lshlrev_b32 v3, 4, v3
  v_lshl_or_b32 v10, v2, 11, v3
  v_and_b32 v2, 7, v0
  v_bfe_u32 v3, v0, 4, 1
  v_lshlrev_b32 v3, 1, v3
  v_xor_b32 v2, v2, v3
  v_lshlrev_b32 v2, 4, v2
  v_lshrrev_b32 v3, 3, v0
  v_lshl_or_b32 v11, v3, 13, v2
  v_xor_b32 v12, 64, v11
  v_lshl_or_b32 v13, v3, 11, v2
  v_xor_b32 v14, 64, v13
  s_lshl_b32 s66, s60, 9
  s_lshl_b32 s67, s60, 21
  s_lshl_b32 s68, s59, 7
  s_add_u32 s67, s67, s68
  s_waitcnt lgkmcnt(0)
  s_mov_b32 s28, s8
  s_and_b32 s29, s9, 0xffff
  s_mov_b32 s30, 0x10000
  s_mov_b32 s31, 0x20000
  s_mov_b32 s32, s14
  s_and_b32 s33, s15, 0xffff
  s_mov_b32 s34, 0x800000
  s_mov_b32 s35, 0x20000
  s_mov_b32 m0, 0x18000
  s_add_u32 s71, s67, 0x0
  buffer_load_dwordx4 v11, s[32:35], s71 offen nt lds
  s_mov_b32 m0, 0x18400
  s_add_u32 s71, s67, 0x10000
  buffer_load_dwordx4 v12, s[32:35], s71 offen nt lds
  s_mov_b32 m0, 0x18800
  s_add_u32 s71, s67, 0x20000
  buffer_load_dwordx4 v11, s[32:35], s71 offen nt lds
  s_mov_b32 m0, 0x18c00
  s_add_u32 s71, s67, 0x30000
  buffer_load_dwordx4 v12, s[32:35], s71 offen nt lds
  v_lshrrev_b32 v2, 4, v0
  v_and_b32 v3, 15, v0
  v_xor_b32 v4, v3, v2
  v_lshlrev_b32 v4, 4, v4
  v_lshl_or_b32 v16, v2, 8, v4
  v_xor_b32 v17, 64, v16
  v_xor_b32 v18, 0x80, v16
  v_xor_b32 v19, 0xc0, v16
  v_lshlrev_b32 v4, 1, v2
  v_xor_b32 v4, v3, v4
  v_lshlrev_b32 v4, 4, v4
  v_lshl_or_b32 v20, v2, 8, v4
  v_xor_b32 v21, 0x80, v20
  v_mov_b32 v1, 131072
  s_lshl_b32 s68, s56, 2
  s_add_u32 s68, s68, s57
  s_lshl_b32 s68, s68, 19
  s_lshl_b32 s69, s58, 16
  s_add_u32 s68, s68, s69
  s_add_u32 s68, s68, 0x60000
  s_lshl_b32 s69, s61, 21
  s_lshl_b32 s70, s62, 16
  s_add_u32 s69, s69, s70
  s_lshl_b32 s70, s63, 7
  s_add_u32 s69, s69, s70
  s_lshr_b32 s70, s2, 4
  s_xor_b32 s70, s70, s2
  s_and_b32 s70, s70, 15
  s_lshl_b32 s70, s70, 12
  s_mov_b32 s36, s10
  s_and_b32 s37, s11, 0xffff
  s_mov_b32 s38, 0x4000000
  s_mov_b32 s39, 0x20000
  s_mov_b32 s40, s12
  s_and_b32 s41, s13, 0xffff
  s_mov_b32 s42, 0x4000000
  s_mov_b32 s43, 0x20000
  s_mov_b32 s44, s16
  s_and_b32 s45, s17, 0xffff
  s_mov_b32 s46, 0x800000
  s_mov_b32 s47, 0x20000
  s_mov_b32 m0, 0x19000
  s_add_u32 s71, s67, 0x40000
  buffer_load_dwordx4 v11, s[32:35], s71 offen nt lds
  s_mov_b32 m0, 0x19400
  s_add_u32 s71, s67, 0x50000
  buffer_load_dwordx4 v12, s[32:35], s71 offen nt lds
  s_mov_b32 m0, 0x19800
  s_add_u32 s71, s67, 0x60000
  buffer_load_dwordx4 v11, s[32:35], s71 offen nt lds
  s_mov_b32 m0, 0x19c00
  s_add_u32 s71, s67, 0x70000
  buffer_load_dwordx4 v12, s[32:35], s71 offen nt lds
  s_mov_b32 m0, 0x1a000
  s_add_u32 s71, s67, 0x80000
  buffer_load_dwordx4 v11, s[32:35], s71 offen nt lds
  s_mov_b32 m0, 0x1a400
  s_add_u32 s71, s67, 0x90000
  buffer_load_dwordx4 v12, s[32:35], s71 offen nt lds
  s_mov_b32 m0, 0x1a800
  s_add_u32 s71, s67, 0xa0000
  buffer_load_dwordx4 v11, s[32:35], s71 offen nt lds
  s_mov_b32 m0, 0x1ac00
  s_add_u32 s71, s67, 0xb0000
  buffer_load_dwordx4 v12, s[32:35], s71 offen nt lds
  s_mov_b32 m0, 0x1b000
  s_add_u32 s71, s67, 0xc0000
  buffer_load_dwordx4 v11, s[32:35], s71 offen nt lds
  s_mov_b32 m0, 0x1b400
  s_add_u32 s71, s67, 0xd0000
  buffer_load_dwordx4 v12, s[32:35], s71 offen nt lds
  s_mov_b32 m0, 0x1b800
  s_add_u32 s71, s67, 0xe0000
  buffer_load_dwordx4 v11, s[32:35], s71 offen nt lds
  s_mov_b32 m0, 0x1bc00
  s_add_u32 s71, s67, 0xf0000
  buffer_load_dwordx4 v12, s[32:35], s71 offen nt lds
  s_mov_b32 m0, 0x1c000
  s_add_u32 s71, s67, 0x100000
  buffer_load_dwordx4 v11, s[32:35], s71 offen nt lds
  s_mov_b32 m0, 0x1c400
  s_add_u32 s71, s67, 0x110000
  buffer_load_dwordx4 v12, s[32:35], s71 offen nt lds
  s_mov_b32 m0, 0x1c800
  s_add_u32 s71, s67, 0x120000
  buffer_load_dwordx4 v11, s[32:35], s71 offen nt lds
  s_mov_b32 m0, 0x1cc00
  s_add_u32 s71, s67, 0x130000
  buffer_load_dwordx4 v12, s[32:35], s71 offen nt lds
  s_mov_b32 m0, 0x1d000
  s_add_u32 s71, s67, 0x140000
  buffer_load_dwordx4 v11, s[32:35], s71 offen nt lds
  s_mov_b32 m0, 0x1d400
  s_add_u32 s71, s67, 0x150000
  buffer_load_dwordx4 v12, s[32:35], s71 offen nt lds
  s_mov_b32 m0, 0x1d800
  s_add_u32 s71, s67, 0x160000
  buffer_load_dwordx4 v11, s[32:35], s71 offen nt lds
  s_mov_b32 m0, 0x1dc00
  s_add_u32 s71, s67, 0x170000
  buffer_load_dwordx4 v12, s[32:35], s71 offen nt lds
  s_barrier
  s_mov_b32 m0, 0x1e000
  s_add_u32 s71, s67, 0x180000
  buffer_load_dwordx4 v11, s[32:35], s71 offen nt lds
  s_mov_b32 m0, 0x1e400
  s_add_u32 s71, s67, 0x190000
  buffer_load_dwordx4 v12, s[32:35], s71 offen nt lds
  s_mov_b32 m0, 0x1e800
  s_add_u32 s71, s67, 0x1a0000
  buffer_load_dwordx4 v11, s[32:35], s71 offen nt lds
  s_mov_b32 m0, 0x1ec00
  s_add_u32 s71, s67, 0x1b0000
  buffer_load_dwordx4 v12, s[32:35], s71 offen nt lds
  s_mov_b32 m0, 0x1f000
  s_add_u32 s71, s67, 0x1c0000
  buffer_load_dwordx4 v11, s[32:35], s71 offen nt lds
  s_mov_b32 m0, 0x1f400
  s_add_u32 s71, s67, 0x1d0000
  buffer_load_dwordx4 v12, s[32:35], s71 offen nt lds
  s_mov_b32 m0, 0x1f800
  s_add_u32 s71, s67, 0x1e0000
  buffer_load_dwordx4 v11, s[32:35], s71 offen nt lds
  s_mov_b32 m0, 0x1fc00
  s_add_u32 s71, s67, 0x1f0000
  buffer_load_dwordx4 v12, s[32:35], s71 offen nt lds
  s_mov_b32 m0, 0x14000
  s_add_u32 s71, s66, 0x0
  v_xor_b32 v22, 0x0, v10
  buffer_load_dwordx4 v22, s[28:31], s71 offen  lds
  s_mov_b32 m0, 0x14400
  s_add_u32 s71, s66, 0x1000
  v_xor_b32 v22, 0x20, v10
  buffer_load_dwordx4 v22, s[28:31], s71 offen  lds
  s_mov_b32 m0, 0x14800
  s_add_u32 s71, s66, 0x2000
  v_xor_b32 v22, 0x40, v10
  buffer_load_dwordx4 v22, s[28:31], s71 offen  lds
  s_mov_b32 m0, 0x14c00
  s_add_u32 s71, s66, 0x3000
  v_xor_b32 v22, 0x60, v10
  buffer_load_dwordx4 v22, s[28:31], s71 offen  lds
  s_mov_b32 m0, 0x15000
  s_add_u32 s71, s66, 0x4000
  v_xor_b32 v22, 0x80, v10
  buffer_load_dwordx4 v22, s[28:31], s71 offen  lds
  s_mov_b32 m0, 0x15400
  s_add_u32 s71, s66, 0x5000
  v_xor_b32 v22, 0xa0, v10
  buffer_load_dwordx4 v22, s[28:31], s71 offen  lds
  s_mov_b32 m0, 0x15800
  s_add_u32 s71, s66, 0x6000
  v_xor_b32 v22, 0xc0, v10
  buffer_load_dwordx4 v22, s[28:31], s71 offen  lds
  s_mov_b32 m0, 0x15c00
  s_add_u32 s71, s66, 0x7000
  v_xor_b32 v22, 0xe0, v10
  buffer_load_dwordx4 v22, s[28:31], s71 offen  lds
  s_mov_b32 m0, 0x16000
  s_add_u32 s71, s66, 0x8000
  v_xor_b32 v22, 0x0, v10
  buffer_load_dwordx4 v22, s[28:31], s71 offen  lds
  s_mov_b32 m0, 0x16400
  s_add_u32 s71, s66, 0x9000
  v_xor_b32 v22, 0x20, v10
  buffer_load_dwordx4 v22, s[28:31], s71 offen  lds
  s_mov_b32 m0, 0x16800
  s_add_u32 s71, s66, 0xa000
  v_xor_b32 v22, 0x40, v10
  buffer_load_dwordx4 v22, s[28:31], s71 offen  lds
  s_mov_b32 m0, 0x16c00
  s_add_u32 s71, s66, 0xb000
  v_xor_b32 v22, 0x60, v10
  buffer_load_dwordx4 v22, s[28:31], s71 offen  lds
  s_mov_b32 m0, 0x17000
  s_add_u32 s71, s66, 0xc000
  v_xor_b32 v22, 0x80, v10
  buffer_load_dwordx4 v22, s[28:31], s71 offen  lds
  s_mov_b32 m0, 0x17400
  s_add_u32 s71, s66, 0xd000
  v_xor_b32 v22, 0xa0, v10
  buffer_load_dwordx4 v22, s[28:31], s71 offen  lds
  s_mov_b32 m0, 0x17800
  s_add_u32 s71, s66, 0xe000
  v_xor_b32 v22, 0xc0, v10
  buffer_load_dwordx4 v22, s[28:31], s71 offen  lds
  s_mov_b32 m0, 0x17c00
  s_add_u32 s71, s66, 0xf000
  v_xor_b32 v22, 0xe0, v10
  buffer_load_dwordx4 v22, s[28:31], s71 offen  lds
  s_waitcnt vmcnt(44)
  v_mov_b32 v2, 4
  ds_write_b32 v1, v2 offset:0
  s_add_u32 s71, s70, 0x0
  s_and_b32 s71, s71, 0xffff
  s_add_u32 s71, s71, s68
  s_mov_b32 m0, 0x0
  s_nop 0
  buffer_load_dwordx4 v16, s[36:39], s71 offen nt lds
  buffer_load_dwordx4 v17, s[36:39], s71 offen offset:1024 nt lds
  buffer_load_dwordx4 v18, s[36:39], s71 offen offset:2048 nt lds
  buffer_load_dwordx4 v19, s[36:39], s71 offen offset:3072 nt lds
  s_waitcnt vmcnt(44)
  v_mov_b32 v2, 8
  ds_write_b32 v1, v2 offset:0
  s_add_u32 s71, s70, 0x1000
  s_and_b32 s71, s71, 0xffff
  s_add_u32 s71, s71, s68
  s_mov_b32 m0, 0x1000
  s_nop 0
  buffer_load_dwordx4 v16, s[36:39], s71 offen nt lds
  buffer_load_dwordx4 v17, s[36:39], s71 offen offset:1024 nt lds
  buffer_load_dwordx4 v18, s[36:39], s71 offen offset:2048 nt lds
  buffer_load_dwordx4 v19, s[36:39], s71 offen offset:3072 nt lds
  s_waitcnt vmcnt(44)
  v_mov_b32 v2, 12
  ds_write_b32 v1, v2 offset:0
  s_add_u32 s71, s70, 0x2000
  s_and_b32 s71, s71, 0xffff
  s_add_u32 s71, s71, s68
  s_mov_b32 m0, 0x2000
  s_nop 0
  buffer_load_dwordx4 v16, s[36:39], s71 offen nt lds
  buffer_load_dwordx4 v17, s[36:39], s71 offen offset:1024 nt lds
  buffer_load_dwordx4 v18, s[36:39], s71 offen offset:2048 nt lds
  buffer_load_dwordx4 v19, s[36:39], s71 offen offset:3072 nt lds
  s_waitcnt vmcnt(20)
  v_mov_b32 v2, 40
  ds_write_b32 v1, v2 offset:0
  s_add_u32 s71, s70, 0x3000
  s_and_b32 s71, s71, 0xffff
  s_add_u32 s71, s71, s68
  s_mov_b32 m0, 0x3000
  s_nop 0
  buffer_load_dwordx4 v16, s[36:39], s71 offen nt lds
  buffer_load_dwordx4 v17, s[36:39], s71 offen offset:1024 nt lds
  buffer_load_dwordx4 v18, s[36:39], s71 offen offset:2048 nt lds
  buffer_load_dwordx4 v19, s[36:39], s71 offen offset:3072 nt lds
  s_waitcnt vmcnt(20)
  v_mov_b32 v2, 44
  ds_write_b32 v1, v2 offset:0
  s_add_u32 s71, s70, 0x4000
  s_and_b32 s71, s71, 0xffff
  s_add_u32 s71, s71, s68
  s_mov_b32 m0, 0x4000
  s_nop 0
  buffer_load_dwordx4 v16, s[36:39], s71 offen nt lds
  buffer_load_dwordx4 v17, s[36:39], s71 offen offset:1024 nt lds
  buffer_load_dwordx4 v18, s[36:39], s71 offen offset:2048 nt lds
  buffer_load_dwordx4 v19, s[36:39], s71 offen offset:3072 nt lds
  s_waitcnt vmcnt(20)
  v_mov_b32 v2, 48
  ds_write_b32 v1, v2 offset:0
  s_add_u32 s71, s70, 0x5000
  s_and_b32 s71, s71, 0xffff
  s_add_u32 s71, s71, s68
  s_mov_b32 m0, 0x5000
  s_nop 0
  buffer_load_dwordx4 v16, s[36:39], s71 offen nt lds
  buffer_load_dwordx4 v17, s[36:39], s71 offen offset:1024 nt lds
  buffer_load_dwordx4 v18, s[36:39], s71 offen offset:2048 nt lds
  buffer_load_dwordx4 v19, s[36:39], s71 offen offset:3072 nt lds
  s_waitcnt vmcnt(20)
  v_mov_b32 v2, 52
  ds_write_b32 v1, v2 offset:0
  s_add_u32 s71, s70, 0x6000
  s_and_b32 s71, s71, 0xffff
  s_add_u32 s71, s71, s68
  s_mov_b32 m0, 0x6000
  s_nop 0
  buffer_load_dwordx4 v16, s[36:39], s71 offen nt lds
  buffer_load_dwordx4 v17, s[36:39], s71 offen offset:1024 nt lds
  buffer_load_dwordx4 v18, s[36:39], s71 offen offset:2048 nt lds
  buffer_load_dwordx4 v19, s[36:39], s71 offen offset:3072 nt lds
  s_waitcnt vmcnt(20)
  v_mov_b32 v2, 56
  ds_write_b32 v1, v2 offset:0
  s_add_u32 s71, s70, 0x7000
  s_and_b32 s71, s71, 0xffff
  s_add_u32 s71, s71, s68
  s_mov_b32 m0, 0x7000
  s_nop 0
  buffer_load_dwordx4 v16, s[36:39], s71 offen nt lds
  buffer_load_dwordx4 v17, s[36:39], s71 offen offset:1024 nt lds
  buffer_load_dwordx4 v18, s[36:39], s71 offen offset:2048 nt lds
  buffer_load_dwordx4 v19, s[36:39], s71 offen offset:3072 nt lds
  s_waitcnt vmcnt(20)
  v_mov_b32 v2, 60
  ds_write_b32 v1, v2 offset:0
  s_add_u32 s71, s70, 0x8000
  s_and_b32 s71, s71, 0xffff
  s_add_u32 s71, s71, s68
  s_mov_b32 m0, 0x8000
  s_nop 0
  buffer_load_dwordx4 v16, s[36:39], s71 offen nt lds
  buffer_load_dwordx4 v17, s[36:39], s71 offen offset:1024 nt lds
  buffer_load_dwordx4 v18, s[36:39], s71 offen offset:2048 nt lds
  buffer_load_dwordx4 v19, s[36:39], s71 offen offset:3072 nt lds
  s_waitcnt vmcnt(20)
  v_mov_b32 v2, 64
  ds_write_b32 v1, v2 offset:0
  s_add_u32 s71, s70, 0x9000
  s_and_b32 s71, s71, 0xffff
  s_add_u32 s71, s71, s68
  s_mov_b32 m0, 0x9000
  s_nop 0
  buffer_load_dwordx4 v16, s[36:39], s71 offen nt lds
  buffer_load_dwordx4 v17, s[36:39], s71 offen offset:1024 nt lds
  buffer_load_dwordx4 v18, s[36:39], s71 offen offset:2048 nt lds
  buffer_load_dwordx4 v19, s[36:39], s71 offen offset:3072 nt lds
  s_waitcnt vmcnt(20)
  v_mov_b32 v2, 68
  ds_write_b32 v1, v2 offset:0
  s_add_u32 s71, s70, 0xa000
  s_and_b32 s71, s71, 0xffff
  s_add_u32 s71, s71, s68
  s_mov_b32 m0, 0xa000
  s_nop 0
  buffer_load_dwordx4 v16, s[36:39], s71 offen nt lds
  buffer_load_dwordx4 v17, s[36:39], s71 offen offset:1024 nt lds
  buffer_load_dwordx4 v18, s[36:39], s71 offen offset:2048 nt lds
  buffer_load_dwordx4 v19, s[36:39], s71 offen offset:3072 nt lds
  s_waitcnt vmcnt(20)
  v_mov_b32 v2, 72
  ds_write_b32 v1, v2 offset:0
  s_add_u32 s71, s70, 0xb000
  s_and_b32 s71, s71, 0xffff
  s_add_u32 s71, s71, s68
  s_mov_b32 m0, 0xb000
  s_nop 0
  buffer_load_dwordx4 v16, s[36:39], s71 offen nt lds
  buffer_load_dwordx4 v17, s[36:39], s71 offen offset:1024 nt lds
  buffer_load_dwordx4 v18, s[36:39], s71 offen offset:2048 nt lds
  buffer_load_dwordx4 v19, s[36:39], s71 offen offset:3072 nt lds
  s_waitcnt vmcnt(20)
  v_mov_b32 v2, 76
  ds_write_b32 v1, v2 offset:0
  s_add_u32 s71, s70, 0xc000
  s_and_b32 s71, s71, 0xffff
  s_add_u32 s71, s71, s68
  s_mov_b32 m0, 0xc000
  s_nop 0
  buffer_load_dwordx4 v16, s[36:39], s71 offen nt lds
  buffer_load_dwordx4 v17, s[36:39], s71 offen offset:1024 nt lds
  buffer_load_dwordx4 v18, s[36:39], s71 offen offset:2048 nt lds
  buffer_load_dwordx4 v19, s[36:39], s71 offen offset:3072 nt lds
  s_waitcnt vmcnt(20)
  v_mov_b32 v2, 80
  ds_write_b32 v1, v2 offset:0
  s_add_u32 s71, s70, 0xd000
  s_and_b32 s71, s71, 0xffff
  s_add_u32 s71, s71, s68
  s_mov_b32 m0, 0xd000
  s_nop 0
  buffer_load_dwordx4 v16, s[36:39], s71 offen nt lds
  buffer_load_dwordx4 v17, s[36:39], s71 offen offset:1024 nt lds
  buffer_load_dwordx4 v18, s[36:39], s71 offen offset:2048 nt lds
  buffer_load_dwordx4 v19, s[36:39], s71 offen offset:3072 nt lds
  s_waitcnt vmcnt(20)
  v_mov_b32 v2, 84
  ds_write_b32 v1, v2 offset:0
  s_add_u32 s71, s70, 0xe000
  s_and_b32 s71, s71, 0xffff
  s_add_u32 s71, s71, s68
  s_mov_b32 m0, 0xe000
  s_nop 0
  buffer_load_dwordx4 v16, s[36:39], s71 offen nt lds
  buffer_load_dwordx4 v17, s[36:39], s71 offen offset:1024 nt lds
  buffer_load_dwordx4 v18, s[36:39], s71 offen offset:2048 nt lds
  buffer_load_dwordx4 v19, s[36:39], s71 offen offset:3072 nt lds
  s_waitcnt vmcnt(20)
  v_mov_b32 v2, 88
  ds_write_b32 v1, v2 offset:0
  s_add_u32 s71, s70, 0xf000
  s_and_b32 s71, s71, 0xffff
  s_add_u32 s71, s71, s68
  s_mov_b32 m0, 0xf000
  s_nop 0
  buffer_load_dwordx4 v16, s[36:39], s71 offen nt lds
  buffer_load_dwordx4 v17, s[36:39], s71 offen offset:1024 nt lds
  buffer_load_dwordx4 v18, s[36:39], s71 offen offset:2048 nt lds
  buffer_load_dwordx4 v19, s[36:39], s71 offen offset:3072 nt lds
  s_waitcnt vmcnt(20)
  v_mov_b32 v2, 92
  ds_write_b32 v1, v2 offset:0
  s_add_u32 s71, s70, 0x0
  s_and_b32 s71, s71, 0xffff
  s_add_u32 s71, s71, s68
  s_mov_b32 m0, 0x10000
  s_nop 0
  buffer_load_dwordx4 v20, s[40:43], s71 offen nt lds
  buffer_load_dwordx4 v21, s[40:43], s71 offen offset:1024 nt lds
  buffer_load_dwordx4 v20, s[40:43], s71 offen offset:2048 nt lds
  buffer_load_dwordx4 v21, s[40:43], s71 offen offset:3072 nt lds
  s_waitcnt vmcnt(20)
  v_mov_b32 v2, 96
  ds_write_b32 v1, v2 offset:0
  s_add_u32 s71, s70, 0x1000
  s_and_b32 s71, s71, 0xffff
  s_add_u32 s71, s71, s68
  s_mov_b32 m0, 0x11000
  s_nop 0
  buffer_load_dwordx4 v20, s[40:43], s71 offen nt lds
  buffer_load_dwordx4 v21, s[40:43], s71 offen offset:1024 nt lds
  buffer_load_dwordx4 v20, s[40:43], s71 offen offset:2048 nt lds
  buffer_load_dwordx4 v21, s[40:43], s71 offen offset:3072 nt lds
  s_waitcnt vmcnt(20)
  v_mov_b32 v2, 100
  ds_write_b32 v1, v2 offset:0
  s_add_u32 s71, s70, 0x2000
  s_and_b32 s71, s71, 0xffff
  s_add_u32 s71, s71, s68
  s_mov_b32 m0, 0x12000
  s_nop 0
  buffer_load_dwordx4 v20, s[40:43], s71 offen nt lds
  buffer_load_dwordx4 v21, s[40:43], s71 offen offset:1024 nt lds
  buffer_load_dwordx4 v20, s[40:43], s71 offen offset:2048 nt lds
  buffer_load_dwordx4 v21, s[40:43], s71 offen offset:3072 nt lds
  s_waitcnt vmcnt(20)
  v_mov_b32 v2, 104
  ds_write_b32 v1, v2 offset:0
  s_add_u32 s71, s70, 0x3000
  s_and_b32 s71, s71, 0xffff
  s_add_u32 s71, s71, s68
  s_mov_b32 m0, 0x13000
  s_nop 0
  buffer_load_dwordx4 v20, s[40:43], s71 offen nt lds
  buffer_load_dwordx4 v21, s[40:43], s71 offen offset:1024 nt lds
  buffer_load_dwordx4 v20, s[40:43], s71 offen offset:2048 nt lds
  buffer_load_dwordx4 v21, s[40:43], s71 offen offset:3072 nt lds
W_1:
  ds_read_b32 v2, v1 offset:4
  s_waitcnt lgkmcnt(0)
  v_readfirstlane_b32 s27, v2
  s_cmp_ge_u32 s27, 4
  s_cbranch_scc1 WD_2
  s_sub_u32 s26, s26, 1
  s_cbranch_scc0 W_1
  s_mov_b32 s26, 0
WD_2:
  s_waitcnt vmcnt(20)
  v_mov_b32 v2, 108
  ds_write_b32 v1, v2 offset:0
  s_add_u32 s71, s70, 0x4000
  s_and_b32 s71, s71, 0xffff
  s_add_u32 s71, s71, s68
  s_mov_b32 m0, 0x14000
  s_nop 0
  buffer_load_dwordx4 v20, s[40:43], s71 offen nt lds
  buffer_load_dwordx4 v21, s[40:43], s71 offen offset:1024 nt lds
  buffer_load_dwordx4 v20, s[40:43], s71 offen offset:2048 nt lds
  buffer_load_dwordx4 v21, s[40:43], s71 offen offset:3072 nt lds
  s_waitcnt vmcnt(20)
  v_mov_b32 v2, 112
  ds_write_b32 v1, v2 offset:0
  s_add_u32 s71, s70, 0x5000
  s_and_b32 s71, s71, 0xffff
  s_add_u32 s71, s71, s68
  s_mov_b32 m0, 0x15000
  s_nop 0
  buffer_load_dwordx4 v20, s[40:43], s71 offen nt lds
  buffer_load_dwordx4 v21, s[40:43], s71 offen offset:1024 nt lds
  buffer_load_dwordx4 v20, s[40:43], s71 offen offset:2048 nt lds
  buffer_load_dwordx4 v21, s[40:43], s71 offen offset:3072 nt lds
  s_waitcnt vmcnt(20)
  v_mov_b32 v2, 116
  ds_write_b32 v1, v2 offset:0
  s_add_u32 s71, s70, 0x6000
  s_and_b32 s71, s71, 0xffff
  s_add_u32 s71, s71, s68
  s_mov_b32 m0, 0x16000
  s_nop 0
  buffer_load_dwordx4 v20, s[40:43], s71 offen nt lds
  buffer_load_dwordx4 v21, s[40:43], s71 offen offset:1024 nt lds
  buffer_load_dwordx4 v20, s[40:43], s71 offen offset:2048 nt lds
  buffer_load_dwordx4 v21, s[40:43], s71 offen offset:3072 nt lds
  s_add_u32 s71, s70, 0x7000
  s_and_b32 s71, s71, 0xffff
  s_add_u32 s71, s71, s68
  s_mov_b32 m0, 0x17000
  s_nop 0
  buffer_load_dwordx4 v20, s[40:43], s71 offen nt lds
  buffer_load_dwordx4 v21, s[40:43], s71 offen offset:1024 nt lds
  buffer_load_dwordx4 v20, s[40:43], s71 offen offset:2048 nt lds
  buffer_load_dwordx4 v21, s[40:43], s71 offen offset:3072 nt lds
  s_add_u32 s71, s70, 0x8000
  s_and_b32 s71, s71, 0xffff
  s_add_u32 s71, s71, s68
  s_mov_b32 m0, 0x18000
  s_nop 0
  buffer_load_dwordx4 v20, s[40:43], s71 offen nt lds
  buffer_load_dwordx4 v21, s[40:43], s71 offen offset:1024 nt lds
  buffer_load_dwordx4 v20, s[40:43], s71 offen offset:2048 nt lds
  buffer_load_dwordx4 v21, s[40:43], s71 offen offset:3072 nt lds
  s_add_u32 s71, s70, 0x9000
  s_and_b32 s71, s71, 0xffff
  s_add_u32 s71, s71, s68
  s_mov_b32 m0, 0x19000
  s_nop 0
  buffer_load_dwordx4 v20, s[40:43], s71 offen nt lds
  buffer_load_dwordx4 v21, s[40:43], s71 offen offset:1024 nt lds
  buffer_load_dwordx4 v20, s[40:43], s71 offen offset:2048 nt lds
  buffer_load_dwordx4 v21, s[40:43], s71 offen offset:3072 nt lds
  s_add_u32 s71, s70, 0xa000
  s_and_b32 s71, s71, 0xffff
  s_add_u32 s71, s71, s68
  s_mov_b32 m0, 0x1a000
  s_nop 0
  buffer_load_dwordx4 v20, s[40:43], s71 offen nt lds
  buffer_load_dwordx4 v21, s[40:43], s71 offen offset:1024 nt lds
  buffer_load_dwordx4 v20, s[40:43], s71 offen offset:2048 nt lds
  buffer_load_dwordx4 v21, s[40:43], s71 offen offset:3072 nt lds
  s_add_u32 s71, s70, 0xb000
  s_and_b32 s71, s71, 0xffff
  s_add_u32 s71, s71, s68
  s_mov_b32 m0, 0x1b000
  s_nop 0
  buffer_load_dwordx4 v20, s[40:43], s71 offen nt lds
  buffer_load_dwordx4 v21, s[40:43], s71 offen offset:1024 nt lds
  buffer_load_dwordx4 v20, s[40:43], s71 offen offset:2048 nt lds
  buffer_load_dwordx4 v21, s[40:43], s71 offen offset:3072 nt lds
  s_waitcnt vmcnt(40)
  v_mov_b32 v2, 120
  ds_write_b32 v1, v2 offset:0
  s_add_u32 s71, s70, 0xc000
  s_and_b32 s71, s71, 0xffff
  s_add_u32 s71, s71, s68
  s_mov_b32 m0, 0x1c000
  s_nop 0
  buffer_load_dwordx4 v20, s[40:43], s71 offen nt lds
  buffer_load_dwordx4 v21, s[40:43], s71 offen offset:1024 nt lds
  buffer_load_dwordx4 v20, s[40:43], s71 offen offset:2048 nt lds
  buffer_load_dwordx4 v21, s[40:43], s71 offen offset:3072 nt lds
  s_waitcnt vmcnt(40)
  v_mov_b32 v2, 124
  ds_write_b32 v1, v2 offset:0
  s_add_u32 s71, s70, 0xd000
  s_and_b32 s71, s71, 0xffff
  s_add_u32 s71, s71, s68
  s_mov_b32 m0, 0x1d000
  s_nop 0
  buffer_load_dwordx4 v20, s[40:43], s71 offen nt lds
  buffer_load_dwordx4 v21, s[40:43], s71 offen offset:1024 nt lds
  buffer_load_dwordx4 v20, s[40:43], s71 offen offset:2048 nt lds
  buffer_load_dwordx4 v21, s[40:43], s71 offen offset:3072 nt lds
  s_waitcnt vmcnt(40)
  v_mov_b32 v2, 128
  ds_write_b32 v1, v2 offset:0
  s_add_u32 s71, s70, 0xe000
  s_and_b32 s71, s71, 0xffff
  s_add_u32 s71, s71, s68
  s_mov_b32 m0, 0x1e000
  s_nop 0
  buffer_load_dwordx4 v20, s[40:43], s71 offen nt lds
  buffer_load_dwordx4 v21, s[40:43], s71 offen offset:1024 nt lds
  buffer_load_dwordx4 v20, s[40:43], s71 offen offset:2048 nt lds
  buffer_load_dwordx4 v21, s[40:43], s71 offen offset:3072 nt lds
  s_waitcnt vmcnt(40)
  v_mov_b32 v2, 132
  ds_write_b32 v1, v2 offset:0
  s_add_u32 s71, s70, 0xf000
  s_and_b32 s71, s71, 0xffff
  s_add_u32 s71, s71, s68
  s_mov_b32 m0, 0x1f000
  s_nop 0
  buffer_load_dwordx4 v20, s[40:43], s71 offen nt lds
  buffer_load_dwordx4 v21, s[40:43], s71 offen offset:1024 nt lds
  buffer_load_dwordx4 v20, s[40:43], s71 offen offset:2048 nt lds
  buffer_load_dwordx4 v21, s[40:43], s71 offen offset:3072 nt lds
W_3:
  ds_read_b32 v2, v1 offset:12
  s_waitcnt lgkmcnt(0)
  v_readfirstlane_b32 s27, v2
  s_cmp_ge_u32 s27, 8
  s_cbranch_scc1 WD_4
  s_sub_u32 s26, s26, 1
  s_cbranch_scc0 W_3
  s_mov_b32 s26, 0
WD_4:
  s_waitcnt vmcnt(40)
  v_mov_b32 v2, 136
  ds_write_b32 v1, v2 offset:0
  s_waitcnt vmcnt(36)
  v_mov_b32 v2, 140
  ds_write_b32 v1, v2 offset:0
  s_waitcnt vmcnt(32)
  v_mov_b32 v2, 144
  ds_write_b32 v1, v2 offset:0
  s_waitcnt vmcnt(28)
  v_mov_b32 v2, 148
  ds_write_b32 v1, v2 offset:0
  s_waitcnt vmcnt(24)
  v_mov_b32 v2, 152
  ds_write_b32 v1, v2 offset:0
  s_add_u32 s71, s69, 0x0
  s_mov_b32 m0, 0x0
  s_nop 0
  buffer_load_dwordx4 v13, s[44:47], s71 offen nt lds
  s_add_u32 s71, s69, 0x4000
  s_mov_b32 m0, 0x400
  s_nop 0
  buffer_load_dwordx4 v14, s[44:47], s71 offen nt lds
  s_add_u32 s71, s69, 0x40000
  s_mov_b32 m0, 0x800
  s_nop 0
  buffer_load_dwordx4 v13, s[44:47], s71 offen nt lds
  s_add_u32 s71, s69, 0x44000
  s_mov_b32 m0, 0xc00
  s_nop 0
  buffer_load_dwordx4 v14, s[44:47], s71 offen nt lds
  s_waitcnt vmcnt(24)
  v_mov_b32 v2, 156
  ds_write_b32 v1, v2 offset:0
  s_add_u32 s71, s69, 0x80000
  s_mov_b32 m0, 0x1000
  s_nop 0
  buffer_load_dwordx4 v13, s[44:47], s71 offen nt lds
  s_add_u32 s71, s69, 0x84000
  s_mov_b32 m0, 0x1400
  s_nop 0
  buffer_load_dwordx4 v14, s[44:47], s71 offen nt lds
  s_add_u32 s71, s69, 0xc0000
  s_mov_b32 m0, 0x1800
  s_nop 0
  buffer_load_dwordx4 v13, s[44:47], s71 offen nt lds
  s_add_u32 s71, s69, 0xc4000
  s_mov_b32 m0, 0x1c00
  s_nop 0
  buffer_load_dwordx4 v14, s[44:47], s71 offen nt lds
  s_waitcnt vmcnt(24)
  v_mov_b32 v2, 160
  ds_write_b32 v1, v2 offset:0
  s_add_u32 s71, s69, 0x100000
  s_mov_b32 m0, 0x2000
  s_nop 0
  buffer_load_dwordx4 v13, s[44:47], s71 offen nt lds
  s_add_u32 s71, s69, 0x104000
  s_mov_b32 m0, 0x2400
  s_nop 0
  buffer_load_dwordx4 v14, s[44:47], s71 offen nt lds
  s_add_u32 s71, s69, 0x140000
  s_mov_b32 m0, 0x2800
  s_nop 0
  buffer_load_dwordx4 v13, s[44:47], s71 offen nt lds
  s_add_u32 s71, s69, 0x144000
  s_mov_b32 m0, 0x2c00
  s_nop 0
  buffer_load_dwordx4 v14, s[44:47], s71 offen nt lds
  s_waitcnt vmcnt(24)
  v_mov_b32 v2, 164
  ds_write_b32 v1, v2 offset:0
  s_add_u32 s71, s69, 0x180000
  s_mov_b32 m0, 0x3000
  s_nop 0
  buffer_load_dwordx4 v13, s[44:47], s71 offen nt lds
  s_add_u32 s71, s69, 0x184000
  s_mov_b32 m0, 0x3400
  s_nop 0
  buffer_load_dwordx4 v14, s[44:47], s71 offen nt lds
  s_add_u32 s71, s69, 0x1c0000
  s_mov_b32 m0, 0x3800
  s_nop 0
  buffer_load_dwordx4 v13, s[44:47], s71 offen nt lds
  s_add_u32 s71, s69, 0x1c4000
  s_mov_b32 m0, 0x3c00
  s_nop 0
  buffer_load_dwordx4 v14, s[44:47], s71 offen nt lds
  s_waitcnt vmcnt(24)
  v_mov_b32 v2, 168
  ds_write_b32 v1, v2 offset:0
  s_add_u32 s71, s69, 0x8000
  s_mov_b32 m0, 0x4000
  s_nop 0
  buffer_load_dwordx4 v13, s[44:47], s71 offen nt lds
  s_add_u32 s71, s69, 0xc000
  s_mov_b32 m0, 0x4400
  s_nop 0
  buffer_load_dwordx4 v14, s[44:47], s71 offen nt lds
  s_add_u32 s71, s69, 0x48000
  s_mov_b32 m0, 0x4800
  s_nop 0
  buffer_load_dwordx4 v13, s[44:47], s71 offen nt lds
  s_add_u32 s71, s69, 0x4c000
  s_mov_b32 m0, 0x4c00
  s_nop 0
  buffer_load_dwordx4 v14, s[44:47], s71 offen nt lds
  s_waitcnt vmcnt(24)
  v_mov_b32 v2, 172
  ds_write_b32 v1, v2 offset:0
  s_add_u32 s71, s69, 0x88000
  s_mov_b32 m0, 0x5000
  s_nop 0
  buffer_load_dwordx4 v13, s[44:47], s71 offen nt lds
  s_add_u32 s71, s69, 0x8c000
  s_mov_b32 m0, 0x5400
  s_nop 0
  buffer_load_dwordx4 v14, s[44:47], s71 offen nt lds
  s_add_u32 s71, s69, 0xc8000
  s_mov_b32 m0, 0x5800
  s_nop 0
  buffer_load_dwordx4 v13, s[44:47], s71 offen nt lds
  s_add_u32 s71, s69, 0xcc000
  s_mov_b32 m0, 0x5c00
  s_nop 0
  buffer_load_dwordx4 v14, s[44:47], s71 offen nt lds
  s_waitcnt vmcnt(24)
  v_mov_b32 v2, 176
  ds_write_b32 v1, v2 offset:0
  s_add_u32 s71, s69, 0x108000
  s_mov_b32 m0, 0x6000
  s_nop 0
  buffer_load_dwordx4 v13, s[44:47], s71 offen nt lds
  s_add_u32 s71, s69, 0x10c000
  s_mov_b32 m0, 0x6400
  s_nop 0
  buffer_load_dwordx4 v14, s[44:47], s71 offen nt lds
  s_add_u32 s71, s69, 0x148000
  s_mov_b32 m0, 0x6800
  s_nop 0
  buffer_load_dwordx4 v13, s[44:47], s71 offen nt lds
  s_add_u32 s71, s69, 0x14c000
  s_mov_b32 m0, 0x6c00
  s_nop 0
  buffer_load_dwordx4 v14, s[44:47], s71 offen nt lds
  s_add_u32 s71, s69, 0x188000
  s_mov_b32 m0, 0x7000
  s_nop 0
  buffer_load_dwordx4 v13, s[44:47], s71 offen nt lds
  s_add_u32 s71, s69, 0x18c000
  s_mov_b32 m0, 0x7400
  s_nop 0
  buffer_load_dwordx4 v14, s[44:47], s71 offen nt lds
  s_add_u32 s71, s69, 0x1c8000
  s_mov_b32 m0, 0x7800
  s_nop 0
  buffer_load_dwordx4 v13, s[44:47], s71 offen nt lds
  s_add_u32 s71, s69, 0x1cc000
  s_mov_b32 m0, 0x7c00
  s_nop 0
  buffer_load_dwordx4 v14, s[44:47], s71 offen nt lds
  s_waitcnt vmcnt(28)
  v_mov_b32 v2, 180
  ds_write_b32 v1, v2 offset:0
  s_waitcnt vmcnt(24)
  v_mov_b32 v2, 184
  ds_write_b32 v1, v2 offset:0
  s_waitcnt vmcnt(20)
  v_mov_b32 v2, 188
  ds_write_b32 v1, v2 offset:0
  s_waitcnt vmcnt(16)
  v_mov_b32 v2, 192
  ds_write_b32 v1, v2 offset:0
  s_waitcnt vmcnt(12)
  v_mov_b32 v2, 196
  ds_write_b32 v1, v2 offset:0
  s_waitcnt vmcnt(8)
  v_mov_b32 v2, 200
  ds_write_b32 v1, v2 offset:0
  s_waitcnt vmcnt(4)
  v_mov_b32 v2, 204
  ds_write_b32 v1, v2 offset:0
  s_waitcnt vmcnt(0)
  v_mov_b32 v2, 208
  ds_write_b32 v1, v2 offset:0
  s_endpgm
.p2align 8
L_worker:
  v_mov_b32 v1, 131072
  v_mov_b32 v3, 1
  s_mov_b32 s69, 0
  s_cmp_eq_u32 s3, 0
  s_cbranch_scc0 P_5
  v_lshl_add_u32 v4, v0, 2, v1
  v_mov_b32 v5, 0
  ds_write_b32 v4, v5
P_5:
  s_lshl_b32 s65, s57, 5
  s_add_u32 s65, s65, s56
  s_lshl_b32 s65, s65, 1
  s_add_u32 s65, s65, s58
  s_waitcnt lgkmcnt(0)
  s_barrier
  s_mov_b32 s48, s22
  s_and_b32 s49, s23, 0xffff
  s_mov_b32 s50, 0x10000000
  s_mov_b32 s51, 0x20000
  s_add_u32 s4, s22, 0x0
  s_addc_u32 s5, s23, 0
  s_load_dword s24, s[4:5], 0
  s_mov_b32 s52, s18
  s_and_b32 s53, s19, 0xffff
  s_mov_b32 s54, 0x10000
  s_mov_b32 s55, 0x20000
  s_cmp_eq_u32 s3, 0
  s_cbranch_scc0 P_6
  s_lshl_b32 s27, s65, 11
  s_add_u32 s27, s27, 0x300000
  v_lshlrev_b32 v4, 4, v0
  v_add_u32 v4, s27, v4
  v_mov_b32 v8, -1
  v_mov_b32 v9, -1
  v_mov_b32 v10, -1
  v_mov_b32 v11, -1
  buffer_store_dwordx4 v[8:11], v4, s[48:51], 0 offen sc1
  buffer_store_dwordx4 v[8:11], v4, s[48:51], 0 offen offset:1024 sc1
P_6:
  s_cmp_eq_u32 s3, 5
  s_cbranch_scc0 T_7
  s_lshl_b32 s27, s56, 2
  s_add_u32 s27, s27, s57
  s_lshl_b32 s27, s27, 19
  s_lshl_b32 s28, s58, 16
  s_add_u32 s27, s27, s28
  s_add_u32 s27, s27, 0x60000
  v_mov_b32 v4, s27
  s_lshl_b32 s27, s61, 21
  v_mov_b32 v5, s27
  v_mov_b32 v6, 0x0
  s_mov_b64 exec, 1
  global_load_dword v161, v4, s[10:11]
  global_load_dword v162, v4, s[12:13]
  global_load_dword v163, v5, s[16:17]
  s_mov_b64 exec, -1
T_7:
  v_and_b32 v4, 15, v0
  v_lshrrev_b32 v5, 4, v0
  s_lshr_b32 s28, s3, 1
  s_and_b32 s29, s3, 1
  v_lshrrev_b32 v6, 2, v4
  v_lshl_add_u32 v7, v5, 3, v6
  v_lshlrev_b32 v7, 7, v7
  v_bfe_u32 v8, v4, 1, 1
  s_lshl_b32 s27, s28, 1
  v_add_u32 v9, s27, v8
  v_bfe_u32 v10, v4, 3, 1
  v_and_b32 v11, 1, v5
  v_lshl_or_b32 v10, v11, 1, v10
  v_lshlrev_b32 v10, 1, v10
  v_xor_b32 v9, v9, v10
  v_lshl_add_u32 v7, v9, 4, v7
  v_and_b32 v12, 1, v4
  v_lshl_add_u32 v7, v12, 3, v7
  v_add_u32 v128, 0x18000, v7
  v_lshrrev_b32 v7, 2, v4
  v_lshl_add_u32 v7, v5, 3, v7
  v_lshlrev_b32 v7, 7, v7
  s_and_b32 s27, s28, 1
  s_lshl_b32 s27, s27, 2
  v_add_u32 v9, s27, v8
  v_xor_b32 v9, v9, v10
  v_lshl_add_u32 v7, v9, 4, v7
  v_lshl_add_u32 v7, v12, 3, v7
  v_add_u32 v159, 0x18000, v7
  v_xor_b32 v160, 32, v159
  s_lshl_b32 s27, s29, 4
  v_add_u32 v7, s27, v4
  v_lshlrev_b32 v7, 9, v7
  v_xor_b32 v13, v5, v4
  v_lshl_add_u32 v7, v13, 4, v7
  v_add_u32 v129, 0x14000, v7
  v_xor_b32 v130, 0x40, v129
  v_xor_b32 v131, 0x80, v129
  v_xor_b32 v132, 0xc0, v129
  s_lshr_b32 s66, s59, 4
  s_lshl_b32 s66, s66, 13
  s_lshl_b32 s67, s60, 11
  s_add_u32 s66, s66, s67
  s_and_b32 s67, s59, 15
  s_lshl_b32 s67, s67, 7
  s_add_u32 s66, s66, s67
  s_and_b32 s67, s28, 1
  s_lshl_b32 s67, s67, 6
  s_add_u32 s66, s66, s67
  s_lshl_b32 s67, s29, 19
  s_add_u32 s66, s66, s67
  s_add_u32 s66, s66, 0x100000
  v_lshlrev_b32 v7, 15, v4
  v_lshl_add_u32 v7, v5, 4, v7
  v_add_u32 v133, s66, v7
  v_lshlrev_b32 v7, 4, v13
  v_lshl_or_b32 v7, v4, 8, v7
  s_lshl_b32 s27, s3, 13
  v_add_u32 v134, s27, v7
  v_xor_b32 v135, 0x40, v134
  v_xor_b32 v136, 0x80, v134
  v_xor_b32 v137, 0xc0, v134
  v_lshrrev_b32 v8, 5, v0
  v_and_b32 v9, 31, v0
  s_lshl_b32 s66, s56, 2
  s_add_u32 s66, s66, s57
  s_lshl_b32 s66, s66, 13
  s_lshl_b32 s67, s3, 8
  s_add_u32 s66, s66, s67
  s_add_u32 s66, s66, 0x100000
  v_lshlrev_b32 v7, 4, v4
  v_lshl_or_b32 v7, v5, 11, v7
  v_add_u32 v138, s66, v7
  s_lshl_b32 s66, s61, 6
  s_lshl_b32 s67, s3, 3
  s_add_u32 s66, s66, s67
  s_lshl_b32 s66, s66, 2
  s_add_u32 s66, s66, 0x1000
  v_and_b32 v10, 7, v0
  v_lshl_add_u32 v139, v10, 2, s66
  v_bfe_u32 v7, v0, 2, 2
  v_lshlrev_b32 v7, 2, v7
  v_lshrrev_b32 v11, 5, v0
  v_lshl_add_u32 v7, v11, 1, v7
  v_bfe_u32 v11, v0, 1, 1
  v_add_u32 v7, v7, v11
  s_lshl_b32 s27, s3, 1
  v_xor_b32 v7, s27, v7
  v_lshlrev_b32 v7, 4, v7
  v_lshl_or_b32 v7, v12, 3, v7
  v_bfe_u32 v11, v0, 4, 1
  v_lshl_or_b32 v7, v11, 2, v7
  s_lshl_b32 s27, s3, 8
  s_add_u32 s27, s27, 131328
  v_add_u32 v140, s27, v7
  v_lshlrev_b32 v7, 1, v10
  v_xor_b32 v7, v7, v5
  v_lshlrev_b32 v7, 4, v7
  v_lshl_or_b32 v7, v10, 8, v7
  v_add_u32 v141, 131328, v7
  v_xor_b32 v142, 0x40, v141
  v_xor_b32 v143, 0x80, v141
  v_xor_b32 v144, 0xc0, v141
  v_lshlrev_b32 v7, 4, v0
  v_add_u32 v148, 133888, v7
  s_lshl_b32 s27, s3, 10
  v_add_u32 v145, s27, v148
  v_lshlrev_b32 v7, 5, v10
  v_add_u32 v147, 133376, v7
  s_lshl_b32 s27, s3, 2
  v_add_u32 v146, s27, v147
  v_lshl_add_u32 v7, v5, 2, v6
  v_and_b32 v11, 7, v7
  v_lshlrev_b32 v11, 1, v11
  v_bfe_u32 v14, v4, 1, 1
  s_lshl_b32 s27, s3, 1
  v_add_u32 v14, s27, v14
  v_xor_b32 v14, v14, v11
  v_lshlrev_b32 v14, 4, v14
  v_lshl_or_b32 v14, v7, 8, v14
  v_lshl_or_b32 v14, v12, 3, v14
  v_add_u32 v149, 0x10000, v14
  s_lshl_b32 s27, s65, 11
  s_lshl_b32 s66, s3, 8
  s_add_u32 s27, s27, s66
  s_add_u32 s27, s27, 0x300000
  v_lshlrev_b32 v7, 5, v4
  v_lshl_or_b32 v7, v5, 3, v7
  v_add_u32 v150, s27, v7
  s_lshl_b32 s27, s65, 7
  s_add_u32 s27, s27, 0x380000
  v_lshl_add_u32 v158, v0, 4, s27
  s_lshl_b32 s66, s61, 5
  s_lshl_b32 s67, s3, 2
  s_add_u32 s66, s66, s67
  s_lshl_b32 s67, s66, 12
  s_lshl_b32 s27, s62, 9
  s_add_u32 s67, s67, s27
  s_add_u32 s67, s67, 0x300000
  v_lshlrev_b32 v7, 4, v9
  v_lshl_or_b32 v7, v8, 12, v7
  v_add_u32 v151, s67, v7
  s_lshl_b32 s67, s66, 8
  s_add_u32 s67, s67, 0x380000
  v_bfe_u32 v7, v9, 1, 3
  v_lshlrev_b32 v7, 4, v7
  v_lshl_or_b32 v7, v8, 8, v7
  v_add_u32 v152, s67, v7
  s_lshl_b32 s67, s3, 2
  v_add_u32 v7, s67, v8
  v_and_b32 v11, 15, v7
  v_xor_b32 v11, v11, v9
  v_lshlrev_b32 v11, 4, v11
  v_lshl_or_b32 v11, v7, 9, v11
  v_add_u32 v153, 142080, v11
  v_add_u32 v7, 2, v7
  v_and_b32 v11, 15, v7
  v_xor_b32 v11, v11, v9
  v_lshlrev_b32 v11, 4, v11
  v_lshl_or_b32 v11, v7, 9, v11
  v_add_u32 v154, 142080, v11
  s_lshl_b32 s66, s63, 4
  s_lshl_b32 s67, s29, 3
  s_add_u32 s66, s66, s67
  s_lshl_b32 s66, s66, 13
  s_lshl_b32 s67, s64, 9
  s_add_u32 s66, s66, s67
  s_lshl_b32 s67, s28, 6
  s_add_u32 s66, s66, s67
  s_add_u32 s66, s66, 0x400000
  v_lshrrev_b32 v7, 1, v4
  v_lshlrev_b32 v7, 13, v7
  v_lshl_or_b32 v7, v12, 8, v7
  v_lshl_or_b32 v7, v5, 4, v7
  v_add_u32 v155, s66, v7
  s_lshl_b32 s66, s2, 13
  s_lshl_b32 s67, s3, 7
  s_add_u32 s66, s66, s67
  s_add_u32 s66, s66, 0x400000
  v_lshrrev_b32 v7, 3, v0
  v_lshlrev_b32 v7, 9, v7
  v_lshl_or_b32 v7, v10, 4, v7
  v_add_u32 v156, s66, v7
  s_and_b32 s66, s2, 15
  s_lshl_b32 s66, s66, 12
  s_lshl_b32 s67, s28, 11
  s_add_u32 s66, s66, s67
  s_lshr_b32 s67, s2, 4
  s_lshl_b32 s67, s67, 7
  s_add_u32 s66, s66, s67
  s_lshl_b32 s67, s29, 6
  s_add_u32 s66, s66, s67
  v_lshl_add_u32 v157, v10, 3, s66
  s_waitcnt lgkmcnt(0)
  s_add_u32 s24, s24, 0x9e3779b9
  s_and_b32 s25, s24, 0xff
  v_mov_b32 v15, s25
  s_mov_b32 s70, 0xffffff00
  s_cmp_eq_u32 s3, 0
  s_cbranch_scc0 P_8
  s_lshl_b32 s27, s65, 2
  s_add_u32 s27, s27, 0x1000
  v_mov_b32 v4, s27
  v_mov_b32 v5, s24
  s_waitcnt vmcnt(0)
  s_mov_b64 exec, 1
  buffer_store_dword v5, v4, s[48:51], 0 offen sc1
  s_mov_b64 exec, -1
P_8:
  s_cmp_lt_u32 s3, 4
  s_cbranch_scc0 S_9
  s_mov_b32 s28, 0x7fff7fff
  s_mov_b32 s29, 0x08000800
  s_mov_b32 s30, 0xfff
  s_mov_b32 s31, 0x04020100
  s_mov_b32 s32, 0x05020100
  s_mov_b32 s33, 0x06020100
  s_and_b32 s34, s24, 0xffffff
  v_mov_b32 v12, s34
  s_cmp_ge_u32 s69, 48
  s_cbranch_scc1 PD_10
P_11:
  ds_read_b32 v2, v1 offset:0
  s_waitcnt lgkmcnt(0)
  v_readfirstlane_b32 s69, v2
  s_cmp_ge_u32 s69, 48
  s_cbranch_scc1 PD_10
  s_sub_u32 s26, s26, 1
  s_cbranch_scc0 P_11
  s_mov_b32 s26, 0
PD_10:
  ds_read_b128 v[96:99], v129 offset:0
  ds_read_b128 v[100:103], v130 offset:0
  ds_read_b128 v[104:107], v131 offset:0
  ds_read_b128 v[108:111], v132 offset:0
  ds_read_b128 v[112:115], v129 offset:256
  ds_read_b128 v[116:119], v130 offset:256
  ds_read_b128 v[120:123], v131 offset:256
  ds_read_b128 v[124:127], v132 offset:256
  ds_read_b64_tr_b16 v[32:33], v159 offset:0
  ds_read_b64_tr_b16 v[34:35], v159 offset:512
  ds_read_b64_tr_b16 v[64:65], v160 offset:0
  ds_read_b64_tr_b16 v[66:67], v160 offset:512
  ds_read_b64_tr_b16 v[36:37], v159 offset:4096
  ds_read_b64_tr_b16 v[38:39], v159 offset:4608
  ds_read_b64_tr_b16 v[68:69], v160 offset:4096
  ds_read_b64_tr_b16 v[70:71], v160 offset:4608
  ds_read_b64_tr_b16 v[40:41], v159 offset:8192
  ds_read_b64_tr_b16 v[42:43], v159 offset:8704
  ds_read_b64_tr_b16 v[72:73], v160 offset:8192
  ds_read_b64_tr_b16 v[74:75], v160 offset:8704
  ds_read_b64_tr_b16 v[44:45], v159 offset:12288
  ds_read_b64_tr_b16 v[46:47], v159 offset:12800
  ds_read_b64_tr_b16 v[76:77], v160 offset:12288
  ds_read_b64_tr_b16 v[78:79], v160 offset:12800
  ds_read_b64_tr_b16 v[48:49], v159 offset:16384
  ds_read_b64_tr_b16 v[50:51], v159 offset:16896
  ds_read_b64_tr_b16 v[80:81], v160 offset:16384
  ds_read_b64_tr_b16 v[82:83], v160 offset:16896
  ds_read_b64_tr_b16 v[52:53], v159 offset:20480
  ds_read_b64_tr_b16 v[54:55], v159 offset:20992
  ds_read_b64_tr_b16 v[84:85], v160 offset:20480
  ds_read_b64_tr_b16 v[86:87], v160 offset:20992
  ds_read_b64_tr_b16 v[56:57], v159 offset:24576
  ds_read_b64_tr_b16 v[58:59], v159 offset:25088
  ds_read_b64_tr_b16 v[88:89], v160 offset:24576
  ds_read_b64_tr_b16 v[90:91], v160 offset:25088
  ds_read_b64_tr_b16 v[60:61], v159 offset:28672
  ds_read_b64_tr_b16 v[62:63], v159 offset:29184
  ds_read_b64_tr_b16 v[92:93], v160 offset:28672
  ds_read_b64_tr_b16 v[94:95], v160 offset:29184
  s_waitcnt lgkmcnt(0)
  s_mov_b64 exec, 1
  ds_add_u32 v1, v3 offset:4
  s_mov_b64 exec, -1
  v_mfma_f32_16x16x32_bf16 v[16:19], v[32:35], v[96:99], 0
  v_mfma_f32_16x16x32_bf16 v[20:23], v[64:67], v[96:99], 0
  v_mfma_f32_16x16x32_bf16 v[16:19], v[36:39], v[100:103], v[16:19]
  v_mfma_f32_16x16x32_bf16 v[20:23], v[68:71], v[100:103], v[20:23]
  v_mfma_f32_16x16x32_bf16 v[16:19], v[40:43], v[104:107], v[16:19]
  v_mfma_f32_16x16x32_bf16 v[20:23], v[72:75], v[104:107], v[20:23]
  v_mfma_f32_16x16x32_bf16 v[16:19], v[44:47], v[108:111], v[16:19]
  v_mfma_f32_16x16x32_bf16 v[20:23], v[76:79], v[108:111], v[20:23]
  v_mfma_f32_16x16x32_bf16 v[16:19], v[48:51], v[112:115], v[16:19]
  v_mfma_f32_16x16x32_bf16 v[20:23], v[80:83], v[112:115], v[20:23]
  v_mfma_f32_16x16x32_bf16 v[16:19], v[52:55], v[116:119], v[16:19]
  v_mfma_f32_16x16x32_bf16 v[20:23], v[84:87], v[116:119], v[20:23]
  v_mfma_f32_16x16x32_bf16 v[16:19], v[56:59], v[120:123], v[16:19]
  v_mfma_f32_16x16x32_bf16 v[20:23], v[88:91], v[120:123], v[20:23]
  v_mfma_f32_16x16x32_bf16 v[16:19], v[60:63], v[124:127], v[16:19]
  v_mfma_f32_16x16x32_bf16 v[20:23], v[92:95], v[124:127], v[20:23]
  s_nop 7
  v_cvt_pk_bf16_f32 v24, v16, v17
  v_cvt_pk_bf16_f32 v25, v18, v19
  v_cvt_pk_bf16_f32 v26, v20, v21
  v_cvt_pk_bf16_f32 v27, v22, v23
  v_and_b32 v16, s28, v24
  v_and_b32 v17, s28, v25
  v_and_b32 v18, s28, v26
  v_and_b32 v19, s28, v27
  v_pk_max_u16 v20, v16, v17
  v_pk_max_u16 v21, v18, v19
  v_pk_max_u16 v20, v20, v21
  v_lshrrev_b32 v21, 16, v20
  v_and_b32 v20, 0xffff, v20
  v_max_u32 v20, v20, v21
  v_lshrrev_b32 v20, 7, v20
  v_subrev_u32 v20, 15, v20
  v_max_i32 v20, 0, v20
  v_lshlrev_b32 v21, 7, v20
  v_lshl_or_b32 v21, v21, 16, v21
  v_pk_sub_u16 v16, v16, v21 clamp
  v_pk_sub_u16 v17, v17, v21 clamp
  v_pk_sub_u16 v18, v18, v21 clamp
  v_pk_sub_u16 v19, v19, v21 clamp
  v_lshrrev_b32 v24, 4, v24
  v_lshrrev_b32 v25, 4, v25
  v_lshrrev_b32 v26, 4, v26
  v_lshrrev_b32 v27, 4, v27
  v_and_or_b32 v16, v24, s29, v16
  v_and_or_b32 v17, v25, s29, v17
  v_and_or_b32 v18, v26, s29, v18
  v_and_or_b32 v19, v27, s29, v19
  v_lshrrev_b32 v24, 4, v16
  v_lshrrev_b32 v25, 4, v17
  v_lshrrev_b32 v26, 4, v18
  v_lshrrev_b32 v27, 4, v19
  v_bfi_b32 v16, s30, v16, v24
  v_bfi_b32 v17, s30, v17, v25
  v_bfi_b32 v18, s30, v18, v26
  v_bfi_b32 v19, s30, v19, v27
  v_perm_b32 v28, v19, v16, s31
  v_perm_b32 v29, v19, v17, s32
  v_perm_b32 v30, v19, v18, s33
  v_lshl_or_b32 v31, v20, 24, v12
  buffer_store_dwordx4 v[28:31], v133, s[48:51], 0 offen sc1
S_9:
  v_add_u32 v128, 0xfffe8000, v128
  v_add_u32 v129, 0xeb00, v129
  v_add_u32 v130, 0xeb00, v130
  v_add_u32 v131, 0xeb00, v131
  v_add_u32 v132, 0xeb00, v132
  s_mov_b32 s67, 0x2000
  s_cmp_ge_u32 s69, 96
  s_cbranch_scc1 PD_12
P_13:
  ds_read_b32 v2, v1 offset:0
  s_waitcnt lgkmcnt(0)
  v_readfirstlane_b32 s69, v2
  s_cmp_ge_u32 s69, 96
  s_cbranch_scc1 PD_12
  s_sub_u32 s26, s26, 1
  s_cbranch_scc0 P_13
  s_mov_b32 s26, 0
PD_12:
  buffer_load_dwordx4 v[16:19], v138, s[48:51], 0 offen sc1
  buffer_load_dword v11, v139, s[48:51], 0 offen sc1
  s_lshl_b32 s66, s3, 3
  s_add_u32 s66, s66, 56
  s_cmp_ge_u32 s69, s66
  s_cbranch_scc1 PD_14
P_15:
  ds_read_b32 v2, v1 offset:0
  s_waitcnt lgkmcnt(0)
  v_readfirstlane_b32 s69, v2
  s_cmp_ge_u32 s69, s66
  s_cbranch_scc1 PD_14
  s_sub_u32 s26, s26, 1
  s_cbranch_scc0 P_15
  s_mov_b32 s26, 0
PD_14:
  ds_read_b128 v[32:35], v134 offset:0
  ds_read_b128 v[36:39], v135 offset:0
  ds_read_b128 v[40:43], v136 offset:0
  ds_read_b128 v[44:47], v137 offset:0
  ds_read_b128 v[48:51], v134 offset:4096
  ds_read_b128 v[52:55], v135 offset:4096
  ds_read_b128 v[56:59], v136 offset:4096
  ds_read_b128 v[60:63], v137 offset:4096
  s_waitcnt lgkmcnt(0)
  s_mov_b64 exec, 1
  ds_add_u32 v1, v3 offset:12
  s_mov_b64 exec, -1
Q_16:
  s_waitcnt vmcnt(0)
  v_xor_b32 v8, s24, v19
  v_and_b32 v8, 0xffffff, v8
  v_bitop3_b32 v8, v8, v11, s24 bitop3:0xf6
  v_cmp_ne_u32 vcc, 0, v8
  s_cbranch_vccz QD_17
  buffer_load_dwordx4 v[16:19], v138, s[48:51], 0 offen sc1
  buffer_load_dword v11, v139, s[48:51], 0 offen sc1
  s_sub_u32 s26, s26, 1
  s_cbranch_scc0 Q_16
  s_mov_b32 s26, 0
QD_17:
  s_mov_b32 s28, 0x0c0c0703
  s_mov_b32 s29, 0x0c070100
  s_mov_b32 s30, 0x0fff0000
  s_mov_b32 s31, 0xfff
  s_mov_b32 s32, 0x07ff07ff
  s_mov_b32 s33, 0x80008000
  s_mov_b32 s34, 0xffff0000
  v_perm_b32 v20, v17, v16, s28
  v_lshrrev_b32 v21, 24, v19
  v_perm_b32 v19, v18, v20, s29
  v_lshlrev_b32 v21, 7, v21
  v_lshl_or_b32 v21, v21, 16, v21
  v_mov_b32 v22, 0x00010001
  v_lshlrev_b32 v24, 4, v16
  v_lshlrev_b32 v25, 4, v17
  v_lshlrev_b32 v26, 4, v18
  v_lshlrev_b32 v27, 4, v19
  v_and_b32 v24, s30, v24
  v_and_b32 v25, s30, v25
  v_and_b32 v26, s30, v26
  v_and_b32 v27, s30, v27
  v_and_or_b32 v16, v16, s31, v24
  v_and_or_b32 v17, v17, s31, v25
  v_and_or_b32 v18, v18, s31, v26
  v_and_or_b32 v19, v19, s31, v27
  v_lshlrev_b32 v24, 4, v16
  v_lshlrev_b32 v25, 4, v17
  v_lshlrev_b32 v26, 4, v18
  v_lshlrev_b32 v27, 4, v19
  v_and_b32 v16, s32, v16
  v_and_b32 v17, s32, v17
  v_and_b32 v18, s32, v18
  v_and_b32 v19, s32, v19
  v_pk_min_u16 v28, v16, v22
  v_pk_min_u16 v29, v17, v22
  v_pk_min_u16 v30, v18, v22
  v_pk_min_u16 v31, v19, v22
  v_pk_add_u16 v16, v16, v21
  v_pk_add_u16 v17, v17, v21
  v_pk_add_u16 v18, v18, v21
  v_pk_add_u16 v19, v19, v21
  v_pk_mul_lo_u16 v16, v16, v28
  v_pk_mul_lo_u16 v17, v17, v29
  v_pk_mul_lo_u16 v18, v18, v30
  v_pk_mul_lo_u16 v19, v19, v31
  v_and_or_b32 v16, v24, s33, v16
  v_and_or_b32 v17, v25, s33, v17
  v_and_or_b32 v18, v26, s33, v18
  v_and_or_b32 v19, v27, s33, v19
  v_lshlrev_b32 v24, 16, v16
  v_and_b32 v25, s34, v16
  v_lshlrev_b32 v26, 16, v17
  v_and_b32 v27, s34, v17
  v_lshlrev_b32 v28, 16, v18
  v_and_b32 v29, s34, v18
  v_lshlrev_b32 v30, 16, v19
  v_and_b32 v31, s34, v19
  s_nop 1
  v_permlane32_swap_b32 v24, v28
  v_permlane32_swap_b32 v25, v29
  v_permlane32_swap_b32 v26, v30
  v_permlane32_swap_b32 v27, v31
  v_add_f32 v24, v24, v28
  v_add_f32 v25, v25, v29
  v_add_f32 v26, v26, v30
  v_add_f32 v27, v27, v31
  s_nop 1
  v_permlane16_swap_b32 v24, v26
  v_permlane16_swap_b32 v25, v27
  v_add_f32 v24, v24, v26
  v_add_f32 v25, v25, v27
  v_cvt_pk_bf16_f32 v16, v24, v25
  ds_write_b32 v140, v16
  s_waitcnt lgkmcnt(0)
  s_mov_b64 exec, 1
  ds_add_u32 v1, v3 offset:8
  s_mov_b64 exec, -1
W_18:
  ds_read_b32 v2, v1 offset:8
  s_waitcnt lgkmcnt(0)
  v_readfirstlane_b32 s27, v2
  s_cmp_ge_u32 s27, 8
  s_cbranch_scc1 WD_19
  s_sub_u32 s26, s26, 1
  s_cbranch_scc0 W_18
  s_mov_b32 s26, 0
WD_19:
  ds_read_b128 v[64:67], v141
  ds_read_b128 v[68:71], v142
  ds_read_b128 v[72:75], v143
  ds_read_b128 v[76:79], v144
  s_mov_b32 s66, 0x3e0293ee
  s_waitcnt lgkmcnt(0)
  v_mfma_f32_16x16x32_bf16 v[16:19], v[32:35], v[64:67], 0
  v_mfma_f32_16x16x32_bf16 v[20:23], v[48:51], v[64:67], 0
  v_mfma_f32_16x16x32_bf16 v[16:19], v[36:39], v[68:71], v[16:19]
  v_mfma_f32_16x16x32_bf16 v[20:23], v[52:55], v[68:71], v[20:23]
  v_mfma_f32_16x16x32_bf16 v[16:19], v[40:43], v[72:75], v[16:19]
  v_mfma_f32_16x16x32_bf16 v[20:23], v[56:59], v[72:75], v[20:23]
  v_mfma_f32_16x16x32_bf16 v[16:19], v[44:47], v[76:79], v[16:19]
  v_mfma_f32_16x16x32_bf16 v[20:23], v[60:63], v[76:79], v[20:23]
  s_nop 7
  v_max3_f32 v24, v16, v17, v18
  v_max3_f32 v24, v24, v19, v20
  v_max3_f32 v24, v24, v21, v22
  v_max_f32 v24, v24, v23
  v_mov_b32 v25, v24
  s_nop 1
  v_permlane16_swap_b32 v24, v25
  v_max_f32 v24, v24, v25
  v_mov_b32 v25, v24
  s_nop 1
  v_permlane32_swap_b32 v24, v25
  v_max_f32 v24, v24, v25
  v_mul_f32 v24, s66, v24
  v_fma_f32 v16, v16, s66, -v24
  v_fma_f32 v17, v17, s66, -v24
  v_fma_f32 v18, v18, s66, -v24
  v_fma_f32 v19, v19, s66, -v24
  v_fma_f32 v20, v20, s66, -v24
  v_fma_f32 v21, v21, s66, -v24
  v_fma_f32 v22, v22, s66, -v24
  v_fma_f32 v23, v23, s66, -v24
  v_exp_f32 v16, v16
  v_exp_f32 v17, v17
  v_exp_f32 v18, v18
  v_exp_f32 v19, v19
  v_exp_f32 v20, v20
  v_exp_f32 v21, v21
  v_exp_f32 v22, v22
  v_exp_f32 v23, v23
  v_add_f32 v25, v16, v17
  v_add_f32 v26, v18, v19
  v_add_f32 v27, v20, v21
  v_add_f32 v30, v22, v23
  v_cvt_pk_bf16_f32 v16, v16, v17
  v_add_f32 v25, v25, v26
  v_cvt_pk_bf16_f32 v17, v18, v19
  v_add_f32 v27, v27, v30
  v_cvt_pk_bf16_f32 v18, v20, v21
  v_add_f32 v25, v25, v27
  v_cvt_pk_bf16_f32 v19, v22, v23
  ds_write_b128 v145, v[16:19]
  v_mov_b32 v26, v25
  s_nop 1
  v_permlane16_swap_b32 v25, v26
  v_add_f32 v25, v25, v26
  v_mov_b32 v26, v25
  s_nop 1
  v_permlane32_swap_b32 v25, v26
  v_add_f32 v25, v25, v26
  s_mov_b64 exec, 0xff
  ds_write_b32 v146, v24
  ds_write_b32 v146, v25 offset:256
  s_mov_b64 exec, -1
  s_waitcnt lgkmcnt(0)
  s_mov_b64 exec, 1
  ds_add_u32 v1, v3 offset:16
  s_mov_b64 exec, -1
W_20:
  ds_read_b32 v2, v1 offset:16
  s_waitcnt lgkmcnt(0)
  v_readfirstlane_b32 s27, v2
  s_cmp_ge_u32 s27, 8
  s_cbranch_scc1 WD_21
  s_sub_u32 s26, s26, 1
  s_cbranch_scc0 W_20
  s_mov_b32 s26, 0
WD_21:
  ds_read_b128 v[16:19], v147
  ds_read_b128 v[20:23], v147 offset:16
  ds_read_b128 v[24:27], v147 offset:256
  ds_read_b128 v[28:31], v147 offset:272
  ds_read_b128 v[64:67], v148 offset:0
  ds_read_b128 v[68:71], v148 offset:1024
  ds_read_b128 v[72:75], v148 offset:2048
  ds_read_b128 v[76:79], v148 offset:3072
  ds_read_b128 v[80:83], v148 offset:4096
  ds_read_b128 v[84:87], v148 offset:5120
  ds_read_b128 v[88:91], v148 offset:6144
  ds_read_b128 v[92:95], v148 offset:7168
  s_waitcnt lgkmcnt(8)
  v_max3_f32 v4, v16, v17, v18
  v_max3_f32 v4, v4, v19, v20
  v_max3_f32 v4, v4, v21, v22
  v_max_f32 v4, v4, v23
  v_sub_f32 v16, v16, v4
  v_sub_f32 v17, v17, v4
  v_sub_f32 v18, v18, v4
  v_sub_f32 v19, v19, v4
  v_sub_f32 v20, v20, v4
  v_sub_f32 v21, v21, v4
  v_sub_f32 v22, v22, v4
  v_sub_f32 v23, v23, v4
  v_exp_f32 v16, v16
  v_exp_f32 v17, v17
  v_exp_f32 v18, v18
  v_exp_f32 v19, v19
  v_exp_f32 v20, v20
  v_exp_f32 v21, v21
  v_exp_f32 v22, v22
  v_exp_f32 v23, v23
  v_mul_f32 v5, v16, v24
  v_fma_f32 v5, v17, v25, v5
  v_fma_f32 v5, v18, v26, v5
  v_fma_f32 v5, v19, v27, v5
  v_fma_f32 v5, v20, v28, v5
  v_fma_f32 v5, v21, v29, v5
  v_fma_f32 v5, v22, v30, v5
  v_fma_f32 v5, v23, v31, v5
  v_rcp_f32 v6, v5
  s_cmp_eq_u32 s3, 0
  s_cbranch_scc0 P_22
  v_mov_b32 v8, v4
  v_mov_b32 v9, v5
  v_mov_b32 v10, s24
  v_mov_b32 v11, s24
  s_mov_b64 exec, 0xff
  buffer_store_dwordx4 v[8:11], v158, s[48:51], 0 offen sc1
  s_mov_b64 exec, -1
P_22:
  s_nop 0
  v_mul_f32 v16, v16, v6
  v_mul_f32 v17, v17, v6
  v_mul_f32 v18, v18, v6
  v_mul_f32 v19, v19, v6
  v_mul_f32 v20, v20, v6
  v_mul_f32 v21, v21, v6
  v_mul_f32 v22, v22, v6
  v_mul_f32 v23, v23, v6
  s_cmp_ge_u32 s69, 120
  s_cbranch_scc1 PD_23
P_24:
  ds_read_b32 v2, v1 offset:0
  s_waitcnt lgkmcnt(0)
  v_readfirstlane_b32 s69, v2
  s_cmp_ge_u32 s69, 120
  s_cbranch_scc1 PD_23
  s_sub_u32 s26, s26, 1
  s_cbranch_scc0 P_24
  s_mov_b32 s26, 0
PD_23:
  ds_read_b64_tr_b16 v[32:33], v149 offset:0
  ds_read_b64_tr_b16 v[34:35], v149 offset:4096
  s_cmp_ge_u32 s69, 128
  s_cbranch_scc1 PD_25
P_26:
  ds_read_b32 v2, v1 offset:0
  s_waitcnt lgkmcnt(0)
  v_readfirstlane_b32 s69, v2
  s_cmp_ge_u32 s69, 128
  s_cbranch_scc1 PD_25
  s_sub_u32 s26, s26, 1
  s_cbranch_scc0 P_26
  s_mov_b32 s26, 0
PD_25:
  ds_read_b64_tr_b16 v[36:37], v149 offset:8192
  ds_read_b64_tr_b16 v[38:39], v149 offset:12288
  s_waitcnt lgkmcnt(2)
  v_mfma_f32_16x16x32_bf16 v[96:99], v[32:35], v[64:67], 0
  s_cmp_ge_u32 s69, 136
  s_cbranch_scc1 PD_27
P_28:
  ds_read_b32 v2, v1 offset:0
  s_waitcnt lgkmcnt(0)
  v_readfirstlane_b32 s69, v2
  s_cmp_ge_u32 s69, 136
  s_cbranch_scc1 PD_27
  s_sub_u32 s26, s26, 1
  s_cbranch_scc0 P_28
  s_mov_b32 s26, 0
PD_27:
  ds_read_b64_tr_b16 v[40:41], v149 offset:16384
  ds_read_b64_tr_b16 v[42:43], v149 offset:20480
  s_waitcnt lgkmcnt(2)
  v_mfma_f32_16x16x32_bf16 v[100:103], v[36:39], v[68:71], 0
  s_cmp_ge_u32 s69, 144
  s_cbranch_scc1 PD_29
P_30:
  ds_read_b32 v2, v1 offset:0
  s_waitcnt lgkmcnt(0)
  v_readfirstlane_b32 s69, v2
  s_cmp_ge_u32 s69, 144
  s_cbranch_scc1 PD_29
  s_sub_u32 s26, s26, 1
  s_cbranch_scc0 P_30
  s_mov_b32 s26, 0
PD_29:
  ds_read_b64_tr_b16 v[44:45], v149 offset:24576
  ds_read_b64_tr_b16 v[46:47], v149 offset:28672
  s_waitcnt lgkmcnt(2)
  v_mfma_f32_16x16x32_bf16 v[104:107], v[40:43], v[72:75], 0
  v_mul_f32 v8, v96, v16
  v_mul_f32 v9, v97, v16
  v_mul_f32 v10, v98, v16
  v_mul_f32 v11, v99, v16
  s_cmp_ge_u32 s69, 152
  s_cbranch_scc1 PD_31
P_32:
  ds_read_b32 v2, v1 offset:0
  s_waitcnt lgkmcnt(0)
  v_readfirstlane_b32 s69, v2
  s_cmp_ge_u32 s69, 152
  s_cbranch_scc1 PD_31
  s_sub_u32 s26, s26, 1
  s_cbranch_scc0 P_32
  s_mov_b32 s26, 0
PD_31:
  ds_read_b64_tr_b16 v[48:49], v149 offset:32768
  ds_read_b64_tr_b16 v[50:51], v149 offset:36864
  s_waitcnt lgkmcnt(2)
  v_mfma_f32_16x16x32_bf16 v[108:111], v[44:47], v[76:79], 0
  v_fma_f32 v8, v100, v17, v8
  v_fma_f32 v9, v101, v17, v9
  v_fma_f32 v10, v102, v17, v10
  v_fma_f32 v11, v103, v17, v11
  s_cmp_ge_u32 s69, 160
  s_cbranch_scc1 PD_33
P_34:
  ds_read_b32 v2, v1 offset:0
  s_waitcnt lgkmcnt(0)
  v_readfirstlane_b32 s69, v2
  s_cmp_ge_u32 s69, 160
  s_cbranch_scc1 PD_33
  s_sub_u32 s26, s26, 1
  s_cbranch_scc0 P_34
  s_mov_b32 s26, 0
PD_33:
  ds_read_b64_tr_b16 v[52:53], v149 offset:40960
  ds_read_b64_tr_b16 v[54:55], v149 offset:45056
  s_waitcnt lgkmcnt(2)
  v_mfma_f32_16x16x32_bf16 v[112:115], v[48:51], v[80:83], 0
  v_fma_f32 v8, v104, v18, v8
  v_fma_f32 v9, v105, v18, v9
  v_fma_f32 v10, v106, v18, v10
  v_fma_f32 v11, v107, v18, v11
  s_cmp_ge_u32 s69, 168
  s_cbranch_scc1 PD_35
P_36:
  ds_read_b32 v2, v1 offset:0
  s_waitcnt lgkmcnt(0)
  v_readfirstlane_b32 s69, v2
  s_cmp_ge_u32 s69, 168
  s_cbranch_scc1 PD_35
  s_sub_u32 s26, s26, 1
  s_cbranch_scc0 P_36
  s_mov_b32 s26, 0
PD_35:
  ds_read_b64_tr_b16 v[56:57], v149 offset:49152
  ds_read_b64_tr_b16 v[58:59], v149 offset:53248
  s_waitcnt lgkmcnt(2)
  v_mfma_f32_16x16x32_bf16 v[116:119], v[52:55], v[84:87], 0
  v_fma_f32 v8, v108, v19, v8
  v_fma_f32 v9, v109, v19, v9
  v_fma_f32 v10, v110, v19, v10
  v_fma_f32 v11, v111, v19, v11
  s_waitcnt lgkmcnt(0)
  v_mfma_f32_16x16x32_bf16 v[120:123], v[56:59], v[88:91], 0
  v_fma_f32 v8, v112, v20, v8
  v_fma_f32 v9, v113, v20, v9
  v_fma_f32 v10, v114, v20, v10
  v_fma_f32 v11, v115, v20, v11
  s_mov_b32 s66, 0xfffffffe
  s_cmp_ge_u32 s69, 176
  s_cbranch_scc1 PD_37
P_38:
  ds_read_b32 v2, v1 offset:0
  s_waitcnt lgkmcnt(0)
  v_readfirstlane_b32 s69, v2
  s_cmp_ge_u32 s69, 176
  s_cbranch_scc1 PD_37
  s_sub_u32 s26, s26, 1
  s_cbranch_scc0 P_38
  s_mov_b32 s26, 0
PD_37:
  ds_read_b64_tr_b16 v[60:61], v149 offset:57344
  ds_read_b64_tr_b16 v[62:63], v149 offset:61440
  v_fma_f32 v8, v116, v21, v8
  v_fma_f32 v9, v117, v21, v9
  v_fma_f32 v10, v118, v21, v10
  v_fma_f32 v11, v119, v21, v11
  s_nop 1
  v_fma_f32 v8, v120, v22, v8
  v_fma_f32 v9, v121, v22, v9
  v_fma_f32 v10, v122, v22, v10
  v_fma_f32 v11, v123, v22, v11
  s_mov_b32 s36, 0x00ff00ff
  s_waitcnt lgkmcnt(0)
  v_mfma_f32_16x16x32_bf16 v[124:127], v[60:63], v[92:95], 0
  s_nop 7
  v_fma_f32 v8, v124, v23, v8
  v_fma_f32 v9, v125, v23, v9
  v_fma_f32 v10, v126, v23, v10
  v_fma_f32 v11, v127, v23, v11
  v_cvt_pk_bf16_f32 v8, v8, v9
  v_cvt_pk_bf16_f32 v9, v10, v11
  v_min_u32 v8, s66, v8
  v_min_u32 v9, s66, v9
  s_mov_b32 exec_lo, s36
  s_mov_b32 exec_hi, s36
  buffer_store_dwordx2 v[8:9], v150, s[48:51], 0 offen sc1
  s_mov_b64 exec, -1
  s_mov_b32 s68, 0x2000
  buffer_load_dwordx4 v[96:99], v152, s[48:51], 0 offen sc1
  buffer_load_dwordx4 v[100:103], v152, s[48:51], 0 offen offset:128 sc1
  buffer_load_dwordx4 v[104:107], v152, s[48:51], 0 offen offset:512 sc1
  buffer_load_dwordx4 v[108:111], v152, s[48:51], 0 offen offset:640 sc1
M_39:
  s_waitcnt vmcnt(0)
  v_xor_b32 v6, s24, v98
  v_bitop3_b32 v6, v6, v102, s24 bitop3:0xf6
  v_bitop3_b32 v6, v6, v106, s24 bitop3:0xf6
  v_bitop3_b32 v6, v6, v110, s24 bitop3:0xf6
  v_cmp_ne_u32 vcc, 0, v6
  s_cbranch_vccz MD_40
  buffer_load_dwordx4 v[96:99], v152, s[48:51], 0 offen sc1
  buffer_load_dwordx4 v[100:103], v152, s[48:51], 0 offen offset:128 sc1
  buffer_load_dwordx4 v[104:107], v152, s[48:51], 0 offen offset:512 sc1
  buffer_load_dwordx4 v[108:111], v152, s[48:51], 0 offen offset:640 sc1
  s_sub_u32 s26, s26, 1
  s_cbranch_scc0 M_39
  s_mov_b32 s26, 0
MD_40:
  buffer_load_dwordx4 v[112:115], v151, s[48:51], 0 offen sc1
  buffer_load_dwordx4 v[116:119], v151, s[48:51], 0 offen offset:2048 sc1
  buffer_load_dwordx4 v[120:123], v151, s[48:51], s68 offen sc1
  buffer_load_dwordx4 v[124:127], v151, s[48:51], s68 offen offset:2048 sc1
  v_max_f32 v16, v96, v100
  v_sub_f32 v17, v96, v16
  v_sub_f32 v18, v100, v16
  v_exp_f32 v17, v17
  v_exp_f32 v18, v18
  s_nop 0
  v_mul_f32 v17, v17, v97
  v_mul_f32 v18, v18, v101
  v_add_f32 v19, v17, v18
  v_rcp_f32 v19, v19
  s_nop 0
  v_mul_f32 v12, v17, v19
  v_mul_f32 v13, v18, v19
  v_max_f32 v16, v104, v108
  v_sub_f32 v17, v104, v16
  v_sub_f32 v18, v108, v16
  v_exp_f32 v17, v17
  v_exp_f32 v18, v18
  s_nop 0
  v_mul_f32 v17, v17, v105
  v_mul_f32 v18, v18, v109
  v_add_f32 v19, v17, v18
  v_rcp_f32 v19, v19
  s_nop 0
  v_mul_f32 v14, v17, v19
  v_mul_f32 v7, v18, v19
  s_cmp_ge_u32 s69, 208
  s_cbranch_scc1 PD_41
P_42:
  ds_read_b32 v2, v1 offset:0
  s_waitcnt lgkmcnt(0)
  v_readfirstlane_b32 s69, v2
  s_cmp_ge_u32 s69, 208
  s_cbranch_scc1 PD_41
  s_sub_u32 s26, s26, 1
  s_cbranch_scc0 P_42
  s_mov_b32 s26, 0
PD_41:
  ds_read_b64_tr_b16 v[32:33], v128 offset:0
  ds_read_b64_tr_b16 v[34:35], v128 offset:512
  ds_read_b64_tr_b16 v[36:37], v128 offset:4096
  ds_read_b64_tr_b16 v[38:39], v128 offset:4608
  ds_read_b64_tr_b16 v[40:41], v128 offset:8192
  ds_read_b64_tr_b16 v[42:43], v128 offset:8704
  ds_read_b64_tr_b16 v[44:45], v128 offset:12288
  ds_read_b64_tr_b16 v[46:47], v128 offset:12800
  ds_read_b64_tr_b16 v[48:49], v128 offset:16384
  ds_read_b64_tr_b16 v[50:51], v128 offset:16896
  ds_read_b64_tr_b16 v[52:53], v128 offset:20480
  ds_read_b64_tr_b16 v[54:55], v128 offset:20992
  ds_read_b64_tr_b16 v[56:57], v128 offset:24576
  ds_read_b64_tr_b16 v[58:59], v128 offset:25088
  ds_read_b64_tr_b16 v[60:61], v128 offset:28672
  ds_read_b64_tr_b16 v[62:63], v128 offset:29184
O_43:
  s_waitcnt vmcnt(0)
  v_max3_u32 v16, v112, v113, v114
  v_max3_u32 v17, v115, v116, v117
  v_max3_u32 v18, v118, v119, v120
  v_max3_u32 v19, v121, v122, v123
  v_max3_u32 v16, v16, v124, v125
  v_max3_u32 v17, v17, v126, v127
  v_max3_u32 v16, v16, v18, v19
  v_max_u32 v16, v16, v17
  v_cmp_eq_u32 vcc, -1, v16
  s_cbranch_vccz OD_44
  buffer_load_dwordx4 v[112:115], v151, s[48:51], 0 offen sc1
  buffer_load_dwordx4 v[116:119], v151, s[48:51], 0 offen offset:2048 sc1
  buffer_load_dwordx4 v[120:123], v151, s[48:51], s68 offen sc1
  buffer_load_dwordx4 v[124:127], v151, s[48:51], s68 offen offset:2048 sc1
  s_sub_u32 s26, s26, 1
  s_cbranch_scc0 O_43
  s_mov_b32 s26, 0
OD_44:
  s_mov_b32 s66, 0xffff0000
  v_lshlrev_b32 v16, 16, v112
  v_and_b32 v17, s66, v112
  v_lshlrev_b32 v28, 16, v113
  v_and_b32 v29, s66, v113
  v_lshlrev_b32 v18, 16, v116
  v_and_b32 v19, s66, v116
  v_lshlrev_b32 v30, 16, v117
  v_and_b32 v31, s66, v117
  v_pk_mul_f32 v[16:17], v[16:17], v[12:13] op_sel:[0,0] op_sel_hi:[1,0]
  v_pk_mul_f32 v[28:29], v[28:29], v[12:13] op_sel:[0,0] op_sel_hi:[1,0]
  v_pk_fma_f32 v[16:17], v[18:19], v[12:13], v[16:17] op_sel:[0,1,0] op_sel_hi:[1,1,1]
  v_pk_fma_f32 v[28:29], v[30:31], v[12:13], v[28:29] op_sel:[0,1,0] op_sel_hi:[1,1,1]
  v_cvt_pk_bf16_f32 v20, v16, v17
  v_cvt_pk_bf16_f32 v21, v28, v29
  v_lshlrev_b32 v16, 16, v114
  v_and_b32 v17, s66, v114
  v_lshlrev_b32 v28, 16, v115
  v_and_b32 v29, s66, v115
  v_lshlrev_b32 v18, 16, v118
  v_and_b32 v19, s66, v118
  v_lshlrev_b32 v30, 16, v119
  v_and_b32 v31, s66, v119
  v_pk_mul_f32 v[16:17], v[16:17], v[12:13] op_sel:[0,0] op_sel_hi:[1,0]
  v_pk_mul_f32 v[28:29], v[28:29], v[12:13] op_sel:[0,0] op_sel_hi:[1,0]
  v_pk_fma_f32 v[16:17], v[18:19], v[12:13], v[16:17] op_sel:[0,1,0] op_sel_hi:[1,1,1]
  v_pk_fma_f32 v[28:29], v[30:31], v[12:13], v[28:29] op_sel:[0,1,0] op_sel_hi:[1,1,1]
  v_cvt_pk_bf16_f32 v22, v16, v17
  v_cvt_pk_bf16_f32 v23, v28, v29
  ds_write_b128 v153, v[20:23]
  v_lshlrev_b32 v16, 16, v120
  v_and_b32 v17, s66, v120
  v_lshlrev_b32 v28, 16, v121
  v_and_b32 v29, s66, v121
  v_lshlrev_b32 v18, 16, v124
  v_and_b32 v19, s66, v124
  v_lshlrev_b32 v30, 16, v125
  v_and_b32 v31, s66, v125
  v_pk_mul_f32 v[16:17], v[16:17], v[14:15] op_sel:[0,0] op_sel_hi:[1,0]
  v_pk_mul_f32 v[28:29], v[28:29], v[14:15] op_sel:[0,0] op_sel_hi:[1,0]
  v_pk_fma_f32 v[16:17], v[18:19], v[6:7], v[16:17] op_sel:[0,1,0] op_sel_hi:[1,1,1]
  v_pk_fma_f32 v[28:29], v[30:31], v[6:7], v[28:29] op_sel:[0,1,0] op_sel_hi:[1,1,1]
  v_cvt_pk_bf16_f32 v24, v16, v17
  v_cvt_pk_bf16_f32 v25, v28, v29
  v_lshlrev_b32 v16, 16, v122
  v_and_b32 v17, s66, v122
  v_lshlrev_b32 v28, 16, v123
  v_and_b32 v29, s66, v123
  v_lshlrev_b32 v18, 16, v126
  v_and_b32 v19, s66, v126
  v_lshlrev_b32 v30, 16, v127
  v_and_b32 v31, s66, v127
  v_pk_mul_f32 v[16:17], v[16:17], v[14:15] op_sel:[0,0] op_sel_hi:[1,0]
  v_pk_mul_f32 v[28:29], v[28:29], v[14:15] op_sel:[0,0] op_sel_hi:[1,0]
  v_pk_fma_f32 v[16:17], v[18:19], v[6:7], v[16:17] op_sel:[0,1,0] op_sel_hi:[1,1,1]
  v_pk_fma_f32 v[28:29], v[30:31], v[6:7], v[28:29] op_sel:[0,1,0] op_sel_hi:[1,1,1]
  v_cvt_pk_bf16_f32 v26, v16, v17
  v_cvt_pk_bf16_f32 v27, v28, v29
  ds_write_b128 v154, v[24:27]
  s_waitcnt lgkmcnt(0)
  s_barrier
  ds_read_b128 v[64:67], v129 offset:0
  ds_read_b128 v[68:71], v130 offset:0
  ds_read_b128 v[72:75], v131 offset:0
  ds_read_b128 v[76:79], v132 offset:0
  ds_read_b128 v[80:83], v129 offset:256
  ds_read_b128 v[84:87], v130 offset:256
  ds_read_b128 v[88:91], v131 offset:256
  ds_read_b128 v[92:95], v132 offset:256
  s_waitcnt lgkmcnt(7)
  v_mfma_f32_16x16x32_bf16 v[28:31], v[32:35], v[64:67], 0
  s_waitcnt lgkmcnt(6)
  v_mfma_f32_16x16x32_bf16 v[28:31], v[36:39], v[68:71], v[28:31]
  s_waitcnt lgkmcnt(5)
  v_mfma_f32_16x16x32_bf16 v[28:31], v[40:43], v[72:75], v[28:31]
  s_waitcnt lgkmcnt(4)
  v_mfma_f32_16x16x32_bf16 v[28:31], v[44:47], v[76:79], v[28:31]
  s_waitcnt lgkmcnt(3)
  v_mfma_f32_16x16x32_bf16 v[28:31], v[48:51], v[80:83], v[28:31]
  s_waitcnt lgkmcnt(2)
  v_mfma_f32_16x16x32_bf16 v[28:31], v[52:55], v[84:87], v[28:31]
  s_waitcnt lgkmcnt(1)
  v_mfma_f32_16x16x32_bf16 v[28:31], v[56:59], v[88:91], v[28:31]
  s_waitcnt lgkmcnt(0)
  v_mfma_f32_16x16x32_bf16 v[28:31], v[60:63], v[92:95], v[28:31]
  s_nop 7
  v_and_or_b32 v28, v28, s70, v15
  v_and_or_b32 v29, v29, s70, v15
  v_and_or_b32 v30, v30, s70, v15
  v_and_or_b32 v31, v31, s70, v15
  buffer_store_dwordx4 v[28:31], v155, s[48:51], 0 offen sc1
  s_cmp_lt_u32 s3, 4
  s_cbranch_scc0 L_wdone
  s_mov_b32 s67, 0x1000
  s_waitcnt vmcnt(0)
F_45:
  buffer_load_dwordx4 v[16:19], v156, s[48:51], 0 offen sc1
  buffer_load_dwordx4 v[20:23], v156, s[48:51], s67 offen sc1
  s_waitcnt vmcnt(0)
  v_xor_b32 v8, v16, v15
  v_bitop3_b32 v8, v8, v17, v15 bitop3:0xf6
  v_bitop3_b32 v8, v8, v18, v15 bitop3:0xf6
  v_bitop3_b32 v8, v8, v19, v15 bitop3:0xf6
  v_bitop3_b32 v8, v8, v20, v15 bitop3:0xf6
  v_bitop3_b32 v8, v8, v21, v15 bitop3:0xf6
  v_bitop3_b32 v8, v8, v22, v15 bitop3:0xf6
  v_bitop3_b32 v8, v8, v23, v15 bitop3:0xf6
  v_and_b32 v8, 0xff, v8
  v_cmp_ne_u32 vcc, 0, v8
  s_cbranch_vccz FD_46
  s_sub_u32 s26, s26, 1
  s_cbranch_scc0 F_45
  s_mov_b32 s26, 0
FD_46:
  v_and_b32 v16, s70, v16
  v_and_b32 v17, s70, v17
  v_and_b32 v18, s70, v18
  v_and_b32 v19, s70, v19
  v_and_b32 v20, s70, v20
  v_and_b32 v21, s70, v21
  v_and_b32 v22, s70, v22
  v_and_b32 v23, s70, v23
  v_add_f32 v16, v16, v20
  v_add_f32 v17, v17, v21
  v_add_f32 v18, v18, v22
  v_add_f32 v19, v19, v23
  s_nop 0
  v_add_f32_dpp v16, v16, v16 row_ror:8 row_mask:0xf bank_mask:0xf
  v_add_f32_dpp v17, v17, v17 row_ror:8 row_mask:0xf bank_mask:0xf
  v_add_f32_dpp v18, v18, v18 row_ror:8 row_mask:0xf bank_mask:0xf
  v_add_f32_dpp v19, v19, v19 row_ror:8 row_mask:0xf bank_mask:0xf
  v_mov_b32 v20, v16
  v_mov_b32 v21, v17
  v_mov_b32 v22, v18
  v_mov_b32 v23, v19
  s_nop 0
  v_permlane16_swap_b32 v16, v20
  v_permlane16_swap_b32 v17, v21
  v_permlane16_swap_b32 v18, v22
  v_permlane16_swap_b32 v19, v23
  v_add_f32 v16, v16, v20
  v_add_f32 v17, v17, v21
  v_add_f32 v18, v18, v22
  v_add_f32 v19, v19, v23
  v_mov_b32 v20, v16
  v_mov_b32 v21, v17
  v_mov_b32 v22, v18
  v_mov_b32 v23, v19
  s_nop 0
  v_permlane32_swap_b32 v16, v20
  v_permlane32_swap_b32 v17, v21
  v_permlane32_swap_b32 v18, v22
  v_permlane32_swap_b32 v19, v23
  v_add_f32 v16, v16, v20
  v_add_f32 v17, v17, v21
  v_add_f32 v18, v18, v22
  v_add_f32 v19, v19, v23
  v_cvt_pk_bf16_f32 v16, v16, v17
  v_cvt_pk_bf16_f32 v17, v18, v19
  s_mov_b64 exec, 0xff
  buffer_store_dwordx2 v[16:17], v157, s[52:55], 0 offen
  s_mov_b64 exec, -1
L_wdone:
  s_or_b32 s27, s2, s3
  s_cmp_eq_u32 s27, 0
  s_cbranch_scc0 E_47
  v_mov_b32 v4, 0
  v_mov_b32 v5, s24
  s_mov_b64 exec, 1
  buffer_store_dword v5, v4, s[48:51], 0 offen sc1
  s_mov_b64 exec, -1
E_47:
  s_endpgm
L_end:
  s_endpgm
L_code_end:
.section .rodata,"a"
.p2align 6
.amdhsa_kernel standalone__sliding_block_cached__sampling_kernel
  .amdhsa_next_free_vgpr 168
  .amdhsa_next_free_sgpr 102
  .amdhsa_accum_offset 168
  .amdhsa_group_segment_fixed_size 0
  .amdhsa_kernarg_size 64
  .amdhsa_user_sgpr_count 2
  .amdhsa_user_sgpr_kernarg_segment_ptr 1
  .amdhsa_system_sgpr_workgroup_id_x 1
.end_amdhsa_kernel
```
